```python
import torch

def _softmax(x, axis=-1):
    return torch.softmax(x, dim=axis)
def _gelu(x):
    return torch.nn.functional.gelu(x, approximate="tanh")
def _silu(x):
    return torch.nn.functional.silu(x)
def _sigmoid(x):
    return torch.sigmoid(x)
def _layernorm(x, axis=-1, eps=1e-5):
    m = x.mean(dim=axis, keepdim=True)
    v = x.var(dim=axis, keepdim=True, unbiased=False)
    return (x - m) / torch.sqrt(v + eps)
def _scatter_add(tgt, idx, src, axis=0):
    return tgt.clone().index_add_(axis, idx, src)
def _segment_sum(src, seg, n):
    out = torch.zeros((n,) + src.shape[1:], dtype=src.dtype)
    return out.index_add_(0, seg, src)
def _pad(x, pw):
    flat = tuple(v for pair in reversed(pw) for v in pair)
    return torch.nn.functional.pad(x, flat)

kernel_name = 'parallel_sum__mha_block_cached__swiglu_ffn__decode'

def setup_inputs():

    _w = (lambda a: (lambda t: t.to(torch.bfloat16) if t.is_floating_point() else t)(torch.as_tensor(a)))
    def _A_setup():
        B, Sq, D = 2, 1, 448
        H, Sk, Dh = 16, 8192, 256
        return {
            "x": _w((lambda *s: torch.randn(*s, dtype=torch.bfloat16) * 0.05)(B, Sq, D)),
            "k_cache": _w((lambda *s: torch.randn(*s, dtype=torch.bfloat16) * 3.2)(B, H, Sk, Dh)),
            "v_cache": _w((lambda *s: torch.randn(*s, dtype=torch.bfloat16) * 1.6)(B, H, Sk, Dh)),
            "wq": _w((lambda *s: torch.randn(*s, dtype=torch.bfloat16) * 3.2)(D, H * Dh) * (D ** -0.5)),
            "wo": _w((lambda *s: torch.randn(*s, dtype=torch.bfloat16) * 1.6)(H * Dh, D) * ((H * Dh) ** -0.5)),
        }
    _A_in = _A_setup()

    def _B_setup():
        B, S, D, F = 2, 1, 448, 1792
        return {
            "x": _w((lambda *s: torch.randn(*s, dtype=torch.bfloat16) * 0.05)(B, S, D)),
            "w_gate": _w((lambda *s: torch.randn(*s, dtype=torch.bfloat16) * 0.05)(D, F)),
            "w_up": _w((lambda *s: torch.randn(*s, dtype=torch.bfloat16) * 0.05)(D, F)),
            "w_down": _w((lambda *s: torch.randn(*s, dtype=torch.bfloat16) * 0.05)(F, D)),
        }
    _B_in = _B_setup()

    return {
        "A_x": _A_in["x"],
        "A_k_cache": _A_in["k_cache"],
        "A_v_cache": _A_in["v_cache"],
        "A_wq": _A_in["wq"],
        "A_wo": _A_in["wo"],
        "B_x": _B_in["x"],
        "B_w_gate": _B_in["w_gate"],
        "B_w_up": _B_in["w_up"],
        "B_w_down": _B_in["w_down"],
    }

def reference(A_x, A_k_cache, A_v_cache, A_wq, A_wo, B_x, B_w_gate, B_w_up, B_w_down):
    def _A_ref(x, k_cache, v_cache, wq, wo):
        B, Sq, D = x.shape
        H, Dh = 16, 256
        q = (lambda x, *d: x.permute(*d))((x @ wq).reshape(B, Sq, H, Dh), 0, 2, 1, 3)
        scores = torch.einsum("bhqd,bhkd->bhqk", q, k_cache) * (Dh ** -0.5)
        p = _softmax(scores, axis=-1)
        o = torch.einsum("bhqk,bhkd->bhqd", p, v_cache)
        return (lambda x, *d: x.permute(*d))(o, 0, 2, 1, 3).reshape(B, Sq, H * Dh) @ wo

    def _B_ref(x, w_gate, w_up, w_down):
        g = _silu(x @ w_gate)
        u = x @ w_up
        return (g * u) @ w_down

    x = A_x
    xn = _layernorm(x, axis=-1)
    return x + _A_ref(xn, A_k_cache, A_v_cache, A_wq, A_wo) + _B_ref(xn, B_w_gate, B_w_up, B_w_down)
```

```asm
; @launch grid=(256,1,1) block=(512,1,1) lds=77824
.amdgcn_target "amdgcn-amd-amdhsa--gfx950"
.text
.globl parallel_sum__mha_block_cached__swiglu_ffn__decode_kernel
.p2align 8
.type parallel_sum__mha_block_cached__swiglu_ffn__decode_kernel,@function
parallel_sum__mha_block_cached__swiglu_ffn__decode_kernel:
s_cmp_ge_u32 s2, 256
s_cbranch_scc1 L_end
s_load_dwordx16 s[16:31], s[0:1], 0
s_load_dwordx8 s[32:39], s[0:1], 64
v_and_b32 v1, 63, v0
v_lshrrev_b32 v4, 6, v0
s_nop 0
v_readfirstlane_b32 s6, v4
s_and_b32 s5, s2, 7
s_lshr_b32 s7, s2, 3
s_and_b32 s3, s7, 15
s_lshr_b32 s4, s7, 4
s_and_b32 s4, s4, 1
s_lshl_b32 s8, s7, 22
s_lshl_b32 s9, s5, 19
s_add_u32 s8, s8, s9
s_mov_b32 s11, 0x05040100
s_mov_b32 s12, 0x07060302
s_mov_b32 s13, 0x3db8aa3b
s_mov_b32 s14, 0xffff0000
v_and_b32 v2, 15, v1
v_lshlrev_b32 v2, 9, v2
v_lshrrev_b32 v4, 4, v1
v_lshl_or_b32 v2, v4, 4, v2
v_lshlrev_b32 v3, 4, v1
v_mov_b32 v5, 0x7f000000
v_cmp_gt_u32 vcc, 56, v1
s_nop 1
v_cndmask_b32 v31, v5, v3, vcc
s_waitcnt lgkmcnt(0)
s_mov_b32 s44, s18
s_mov_b32 s45, s19
s_mov_b32 s46, 0x8000000
s_mov_b32 s47, 0x20000
s_mov_b32 s40, s16
s_mov_b32 s41, s17
s_mov_b32 s42, 0x700
s_mov_b32 s43, 0x20000
s_mov_b32 s52, s22
s_mov_b32 s53, s23
s_mov_b32 s54, 0x380000
s_mov_b32 s55, 0x20000
s_mov_b32 s48, s20
s_mov_b32 s49, s21
s_mov_b32 s50, 0x8000000
s_mov_b32 s51, 0x20000
s_mov_b32 s56, s24
s_mov_b32 s57, s25
s_mov_b32 s58, 0x380000
s_mov_b32 s59, 0x20000
s_mov_b32 s64, s32
s_mov_b32 s65, s33
s_mov_b32 s66, 0x188000
s_mov_b32 s67, 0x20000
s_mov_b32 s68, s34
s_mov_b32 s69, s35
s_mov_b32 s70, 0x700
s_mov_b32 s71, 0x20000
s_mov_b32 s72, s36
s_mov_b32 s73, s37
s_mov_b32 s74, 0x100
s_mov_b32 s75, 0x20000
s_mov_b32 s76, s38
s_mov_b32 s77, s39
s_mov_b32 s78, 0x200000
s_mov_b32 s79, 0x20000
s_cmp_lt_u32 s6, 4
s_cselect_b32 s60, s28, s30
s_cselect_b32 s61, s29, s31
s_mov_b32 s62, 0x188000
s_mov_b32 s63, 0x20000
s_sub_u32 s9, s6, 1
s_add_u32 s10, s6, 0
s_lshl_b32 s10, s10, 13
s_add_u32 s20, s8, s10
s_add_u32 s10, s6, 8
s_lshl_b32 s10, s10, 13
s_add_u32 s21, s8, s10
s_add_u32 s10, s6, 16
s_lshl_b32 s10, s10, 13
s_add_u32 s22, s8, s10
s_add_u32 s10, s6, 24
s_lshl_b32 s10, s10, 13
s_add_u32 s23, s8, s10
s_add_u32 s10, s6, 32
s_lshl_b32 s10, s10, 13
s_add_u32 s24, s8, s10
s_add_u32 s10, s6, 40
s_lshl_b32 s10, s10, 13
s_add_u32 s25, s8, s10
s_add_u32 s10, s6, 48
s_lshl_b32 s10, s10, 13
s_add_u32 s26, s8, s10
s_add_u32 s10, s6, 56
s_lshl_b32 s10, s10, 13
s_add_u32 s27, s8, s10
s_mul_i32 s10, s4, 896
buffer_load_dwordx4 v[8:11], v31, s[40:43], s10 offen
v_lshrrev_b32 v5, 2, v1
v_lshlrev_b32 v126, 13, v5
v_and_b32 v6, 3, v1
v_lshl_add_u32 v126, v6, 4, v126
v_lshlrev_b32 v127, 2, v5
s_lshl_b32 s9, s6, 6
v_add_u32 v127, s9, v127
s_mov_b32 s84, s5
s_mov_b32 s86, 0
s_cmp_eq_u32 s6, 0
s_cbranch_scc0 L_nononce
s_memrealtime s[16:17]
v_mov_b32 v125, 64
s_waitcnt lgkmcnt(0)
s_or_b32 s16, s16, 1
v_mov_b32 v122, s16
v_mov_b32 v123, 0
s_mov_b64 exec, 1
buffer_atomic_cmpswap v[122:123], v125, s[72:75], 0 offen sc0
s_mov_b64 exec, -1
L_nononce:
s_lshl_b32 s9, s84, 6
s_lshl_b32 s10, s3, 9
s_add_u32 s9, s9, s10
s_lshl_b32 s10, s6, 17
s_add_u32 s9, s9, s10
buffer_load_dwordx4 v[64:67], v126, s[52:55], s9 offen
s_add_u32 s9, s9, 1048576
buffer_load_dwordx4 v[68:71], v126, s[52:55], s9 offen
s_add_u32 s9, s9, 1048576
buffer_load_dwordx4 v[72:75], v126, s[52:55], s9 offen
s_add_u32 s9, s9, 1048576
buffer_load_dwordx4 v[76:79], v126, s[52:55], s9 offen
s_add_u32 s10, s20, 4096
buffer_load_dwordx4 v[160:163], v3, s[44:47], s20 offen offset:0 nt
buffer_load_dwordx4 v[164:167], v3, s[44:47], s20 offen offset:1024 nt
buffer_load_dwordx4 v[168:171], v3, s[44:47], s20 offen offset:2048 nt
buffer_load_dwordx4 v[172:175], v3, s[44:47], s20 offen offset:3072 nt
buffer_load_dwordx4 v[176:179], v3, s[44:47], s10 offen offset:0 nt
buffer_load_dwordx4 v[180:183], v3, s[44:47], s10 offen offset:1024 nt
buffer_load_dwordx4 v[184:187], v3, s[44:47], s10 offen offset:2048 nt
buffer_load_dwordx4 v[188:191], v3, s[44:47], s10 offen offset:3072 nt
s_waitcnt vmcnt(12)
v_lshlrev_b32 v16, 16, v8
v_and_b32 v17, s14, v8
v_lshlrev_b32 v18, 16, v9
v_and_b32 v19, s14, v9
v_lshlrev_b32 v20, 16, v10
v_and_b32 v21, s14, v10
v_lshlrev_b32 v22, 16, v11
v_and_b32 v23, s14, v11
v_add_f32 v24, v16, v17
v_add_f32 v24, v24, v18
v_add_f32 v24, v24, v19
v_add_f32 v24, v24, v20
v_add_f32 v24, v24, v21
v_add_f32 v24, v24, v22
v_add_f32 v24, v24, v23
s_nop 1
v_add_f32_dpp v25, v24, v24 row_ror:8 row_mask:0xf bank_mask:0xf
v_mov_b32 v24, v25
s_nop 1
v_add_f32_dpp v25, v24, v24 row_ror:4 row_mask:0xf bank_mask:0xf
v_mov_b32 v24, v25
s_nop 1
v_add_f32_dpp v25, v24, v24 row_ror:2 row_mask:0xf bank_mask:0xf
v_mov_b32 v24, v25
s_nop 1
v_add_f32_dpp v25, v24, v24 row_ror:1 row_mask:0xf bank_mask:0xf
v_mov_b32 v24, v25
s_nop 0
v_readlane_b32 s80, v24, 0
v_readlane_b32 s81, v24, 16
v_readlane_b32 s82, v24, 32
v_readlane_b32 s83, v24, 48
s_nop 1
v_mov_b32 v24, s80
v_add_f32 v24, s81, v24
v_add_f32 v24, s82, v24
v_add_f32 v24, s83, v24
v_mul_f32 v25, 0x3b124925, v24
v_mov_b32 v26, 0x43e00000
v_fma_f32 v26, -v25, v26, v24
v_mul_f32 v26, 0x3b124925, v26
v_add_f32 v24, v25, v26
v_mov_b32 v27, 0
v_sub_f32 v25, v16, v24
v_fmac_f32 v27, v25, v25
v_sub_f32 v25, v17, v24
v_fmac_f32 v27, v25, v25
v_sub_f32 v25, v18, v24
v_fmac_f32 v27, v25, v25
v_sub_f32 v25, v19, v24
v_fmac_f32 v27, v25, v25
v_sub_f32 v25, v20, v24
v_fmac_f32 v27, v25, v25
v_sub_f32 v25, v21, v24
v_fmac_f32 v27, v25, v25
v_sub_f32 v25, v22, v24
v_fmac_f32 v27, v25, v25
v_sub_f32 v25, v23, v24
v_fmac_f32 v27, v25, v25
v_cmp_gt_u32 vcc, 56, v1
s_nop 1
v_cndmask_b32 v27, 0, v27, vcc
s_nop 1
v_add_f32_dpp v25, v27, v27 row_ror:8 row_mask:0xf bank_mask:0xf
v_mov_b32 v27, v25
s_nop 1
v_add_f32_dpp v25, v27, v27 row_ror:4 row_mask:0xf bank_mask:0xf
v_mov_b32 v27, v25
s_nop 1
v_add_f32_dpp v25, v27, v27 row_ror:2 row_mask:0xf bank_mask:0xf
v_mov_b32 v27, v25
s_nop 1
v_add_f32_dpp v25, v27, v27 row_ror:1 row_mask:0xf bank_mask:0xf
v_mov_b32 v27, v25
s_nop 0
v_readlane_b32 s80, v27, 0
v_readlane_b32 s81, v27, 16
v_readlane_b32 s82, v27, 32
v_readlane_b32 s83, v27, 48
s_nop 1
v_mov_b32 v27, s80
v_add_f32 v27, s81, v27
v_add_f32 v27, s82, v27
v_add_f32 v27, s83, v27
v_mul_f32 v25, 0x3b124925, v27
v_mov_b32 v26, 0x43e00000
v_fma_f32 v26, -v25, v26, v27
v_mul_f32 v26, 0x3b124925, v26
v_add_f32 v27, v25, v26
v_cvt_pk_bf16_f32 v27, 0, v27
v_cvt_pk_bf16_f32 v24, 0, v24
v_add_f32 v27, 0x3727c5ac, v27
v_cvt_pk_bf16_f32 v27, 0, v27
v_sqrt_f32 v27, v27
s_nop 0
v_cvt_pk_bf16_f32 v27, 0, v27
v_rcp_f32 v28, v27
s_nop 0
v_sub_f32 v16, v16, v24
v_cvt_pk_bf16_f32 v16, 0, v16
v_mul_f32 v25, v16, v28
v_fma_f32 v26, -v25, v27, v16
v_fma_f32 v16, v26, v28, v25
v_sub_f32 v17, v17, v24
v_cvt_pk_bf16_f32 v17, 0, v17
v_mul_f32 v25, v17, v28
v_fma_f32 v26, -v25, v27, v17
v_fma_f32 v17, v26, v28, v25
v_sub_f32 v18, v18, v24
v_cvt_pk_bf16_f32 v18, 0, v18
v_mul_f32 v25, v18, v28
v_fma_f32 v26, -v25, v27, v18
v_fma_f32 v18, v26, v28, v25
v_sub_f32 v19, v19, v24
v_cvt_pk_bf16_f32 v19, 0, v19
v_mul_f32 v25, v19, v28
v_fma_f32 v26, -v25, v27, v19
v_fma_f32 v19, v26, v28, v25
v_sub_f32 v20, v20, v24
v_cvt_pk_bf16_f32 v20, 0, v20
v_mul_f32 v25, v20, v28
v_fma_f32 v26, -v25, v27, v20
v_fma_f32 v20, v26, v28, v25
v_sub_f32 v21, v21, v24
v_cvt_pk_bf16_f32 v21, 0, v21
v_mul_f32 v25, v21, v28
v_fma_f32 v26, -v25, v27, v21
v_fma_f32 v21, v26, v28, v25
v_sub_f32 v22, v22, v24
v_cvt_pk_bf16_f32 v22, 0, v22
v_mul_f32 v25, v22, v28
v_fma_f32 v26, -v25, v27, v22
v_fma_f32 v22, v26, v28, v25
v_sub_f32 v23, v23, v24
v_cvt_pk_bf16_f32 v23, 0, v23
v_mul_f32 v25, v23, v28
v_fma_f32 v26, -v25, v27, v23
v_fma_f32 v23, v26, v28, v25
v_cvt_pk_bf16_f32 v8, v16, v17
v_cvt_pk_bf16_f32 v9, v18, v19
v_cvt_pk_bf16_f32 v10, v20, v21
v_cvt_pk_bf16_f32 v11, v22, v23
v_lshlrev_b32 v16, 16, v8
v_and_b32 v17, s14, v8
v_lshlrev_b32 v18, 16, v9
v_and_b32 v19, s14, v9
v_lshlrev_b32 v20, 16, v10
v_and_b32 v21, s14, v10
v_lshlrev_b32 v22, 16, v11
v_and_b32 v23, s14, v11
v_cmp_gt_u32 vcc, 56, v1
s_nop 1
v_cndmask_b32 v16, 0, v16, vcc
v_cndmask_b32 v17, 0, v17, vcc
v_cndmask_b32 v18, 0, v18, vcc
v_cndmask_b32 v19, 0, v19, vcc
v_cndmask_b32 v20, 0, v20, vcc
v_cndmask_b32 v21, 0, v21, vcc
v_cndmask_b32 v22, 0, v22, vcc
v_cndmask_b32 v23, 0, v23, vcc
v_lshlrev_b32 v25, 5, v1
ds_write_b128 v25, v[16:19] offset:0
ds_write_b128 v25, v[20:23] offset:16
s_waitcnt lgkmcnt(0)
ds_read_b32 v20, v127 offset:0
ds_read_b32 v21, v127 offset:512
ds_read_b32 v22, v127 offset:1024
ds_read_b32 v23, v127 offset:1536
s_branch L_share_body
L_share_loop:
s_lshl_b32 s9, s84, 6
s_lshl_b32 s10, s3, 9
s_add_u32 s9, s9, s10
s_lshl_b32 s10, s6, 17
s_add_u32 s9, s9, s10
buffer_load_dwordx4 v[64:67], v126, s[52:55], s9 offen
s_add_u32 s9, s9, 1048576
buffer_load_dwordx4 v[68:71], v126, s[52:55], s9 offen
s_add_u32 s9, s9, 1048576
buffer_load_dwordx4 v[72:75], v126, s[52:55], s9 offen
s_add_u32 s9, s9, 1048576
buffer_load_dwordx4 v[76:79], v126, s[52:55], s9 offen
s_waitcnt vmcnt(0)
L_share_body:
v_mov_b32 v4, 0
v_mov_b32 v5, 0
v_mov_b32 v6, 0
v_mov_b32 v7, 0
v_mov_b32 v8, 0
v_mov_b32 v9, 0
v_mov_b32 v10, 0
v_mov_b32 v11, 0
s_waitcnt lgkmcnt(0)
s_waitcnt vmcnt(11)
v_lshlrev_b32 v28, 16, v64
v_and_b32 v29, s14, v64
v_fmac_f32 v4, v20, v28
v_fmac_f32 v5, v20, v29
v_lshlrev_b32 v28, 16, v65
v_and_b32 v29, s14, v65
v_fmac_f32 v6, v20, v28
v_fmac_f32 v7, v20, v29
v_lshlrev_b32 v28, 16, v66
v_and_b32 v29, s14, v66
v_fmac_f32 v8, v20, v28
v_fmac_f32 v9, v20, v29
v_lshlrev_b32 v28, 16, v67
v_and_b32 v29, s14, v67
v_fmac_f32 v10, v20, v28
v_fmac_f32 v11, v20, v29
s_waitcnt vmcnt(10)
v_lshlrev_b32 v28, 16, v68
v_and_b32 v29, s14, v68
v_fmac_f32 v4, v21, v28
v_fmac_f32 v5, v21, v29
v_lshlrev_b32 v28, 16, v69
v_and_b32 v29, s14, v69
v_fmac_f32 v6, v21, v28
v_fmac_f32 v7, v21, v29
v_lshlrev_b32 v28, 16, v70
v_and_b32 v29, s14, v70
v_fmac_f32 v8, v21, v28
v_fmac_f32 v9, v21, v29
v_lshlrev_b32 v28, 16, v71
v_and_b32 v29, s14, v71
v_fmac_f32 v10, v21, v28
v_fmac_f32 v11, v21, v29
s_waitcnt vmcnt(9)
v_lshlrev_b32 v28, 16, v72
v_and_b32 v29, s14, v72
v_fmac_f32 v4, v22, v28
v_fmac_f32 v5, v22, v29
v_lshlrev_b32 v28, 16, v73
v_and_b32 v29, s14, v73
v_fmac_f32 v6, v22, v28
v_fmac_f32 v7, v22, v29
v_lshlrev_b32 v28, 16, v74
v_and_b32 v29, s14, v74
v_fmac_f32 v8, v22, v28
v_fmac_f32 v9, v22, v29
v_lshlrev_b32 v28, 16, v75
v_and_b32 v29, s14, v75
v_fmac_f32 v10, v22, v28
v_fmac_f32 v11, v22, v29
s_waitcnt vmcnt(8)
v_lshlrev_b32 v28, 16, v76
v_and_b32 v29, s14, v76
v_fmac_f32 v4, v23, v28
v_fmac_f32 v5, v23, v29
v_lshlrev_b32 v28, 16, v77
v_and_b32 v29, s14, v77
v_fmac_f32 v6, v23, v28
v_fmac_f32 v7, v23, v29
v_lshlrev_b32 v28, 16, v78
v_and_b32 v29, s14, v78
v_fmac_f32 v8, v23, v28
v_fmac_f32 v9, v23, v29
v_lshlrev_b32 v28, 16, v79
v_and_b32 v29, s14, v79
v_fmac_f32 v10, v23, v28
v_fmac_f32 v11, v23, v29
s_nop 1
v_add_f32_dpp v4, v4, v4 row_ror:4 row_mask:0xf bank_mask:0xf
v_add_f32_dpp v5, v5, v5 row_ror:4 row_mask:0xf bank_mask:0xf
v_add_f32_dpp v6, v6, v6 row_ror:4 row_mask:0xf bank_mask:0xf
v_add_f32_dpp v7, v7, v7 row_ror:4 row_mask:0xf bank_mask:0xf
v_add_f32_dpp v8, v8, v8 row_ror:4 row_mask:0xf bank_mask:0xf
v_add_f32_dpp v9, v9, v9 row_ror:4 row_mask:0xf bank_mask:0xf
v_add_f32_dpp v10, v10, v10 row_ror:4 row_mask:0xf bank_mask:0xf
v_add_f32_dpp v11, v11, v11 row_ror:4 row_mask:0xf bank_mask:0xf
s_nop 1
v_add_f32_dpp v4, v4, v4 row_ror:8 row_mask:0xf bank_mask:0xf
v_add_f32_dpp v5, v5, v5 row_ror:8 row_mask:0xf bank_mask:0xf
v_add_f32_dpp v6, v6, v6 row_ror:8 row_mask:0xf bank_mask:0xf
v_add_f32_dpp v7, v7, v7 row_ror:8 row_mask:0xf bank_mask:0xf
v_add_f32_dpp v8, v8, v8 row_ror:8 row_mask:0xf bank_mask:0xf
v_add_f32_dpp v9, v9, v9 row_ror:8 row_mask:0xf bank_mask:0xf
v_add_f32_dpp v10, v10, v10 row_ror:8 row_mask:0xf bank_mask:0xf
v_add_f32_dpp v11, v11, v11 row_ror:8 row_mask:0xf bank_mask:0xf
v_mov_b32 v12, v4
v_mov_b32 v13, v5
v_mov_b32 v14, v6
v_mov_b32 v15, v7
v_mov_b32 v16, v8
v_mov_b32 v17, v9
v_mov_b32 v18, v10
v_mov_b32 v19, v11
s_nop 1
v_permlane16_swap_b32 v4, v12
v_permlane16_swap_b32 v5, v13
v_permlane16_swap_b32 v6, v14
v_permlane16_swap_b32 v7, v15
v_permlane16_swap_b32 v8, v16
v_permlane16_swap_b32 v9, v17
v_permlane16_swap_b32 v10, v18
v_permlane16_swap_b32 v11, v19
s_nop 1
v_add_f32 v4, v4, v12
v_add_f32 v5, v5, v13
v_add_f32 v6, v6, v14
v_add_f32 v7, v7, v15
v_add_f32 v8, v8, v16
v_add_f32 v9, v9, v17
v_add_f32 v10, v10, v18
v_add_f32 v11, v11, v19
v_mov_b32 v12, v4
v_mov_b32 v13, v5
v_mov_b32 v14, v6
v_mov_b32 v15, v7
v_mov_b32 v16, v8
v_mov_b32 v17, v9
v_mov_b32 v18, v10
v_mov_b32 v19, v11
s_nop 1
v_permlane32_swap_b32 v4, v12
v_permlane32_swap_b32 v5, v13
v_permlane32_swap_b32 v6, v14
v_permlane32_swap_b32 v7, v15
v_permlane32_swap_b32 v8, v16
v_permlane32_swap_b32 v9, v17
v_permlane32_swap_b32 v10, v18
v_permlane32_swap_b32 v11, v19
s_nop 1
v_add_f32 v4, v4, v12
v_add_f32 v5, v5, v13
v_add_f32 v6, v6, v14
v_add_f32 v7, v7, v15
v_add_f32 v8, v8, v16
v_add_f32 v9, v9, v17
v_add_f32 v10, v10, v18
v_add_f32 v11, v11, v19
v_lshlrev_b32 v28, 5, v1
s_lshl_b32 s9, s6, 7
v_add_u32 v28, s9, v28
s_mov_b64 exec, 15
ds_write_b128 v28, v[4:7] offset:7168
ds_write_b128 v28, v[8:11] offset:7184
s_mov_b64 exec, -1
s_waitcnt lgkmcnt(0)
s_barrier
s_cmp_eq_u32 s6, 0
s_cbranch_scc1 L_q_w0
s_cmp_eq_u32 s86, 0
s_cbranch_scc0 L_q_w
s_add_u32 s10, s21, 4096
buffer_load_dwordx4 v[192:195], v3, s[44:47], s21 offen offset:0 nt
buffer_load_dwordx4 v[196:199], v3, s[44:47], s21 offen offset:1024 nt
buffer_load_dwordx4 v[200:203], v3, s[44:47], s21 offen offset:2048 nt
buffer_load_dwordx4 v[204:207], v3, s[44:47], s21 offen offset:3072 nt
buffer_load_dwordx4 v[208:211], v3, s[44:47], s10 offen offset:0 nt
buffer_load_dwordx4 v[212:215], v3, s[44:47], s10 offen offset:1024 nt
buffer_load_dwordx4 v[216:219], v3, s[44:47], s10 offen offset:2048 nt
buffer_load_dwordx4 v[220:223], v3, s[44:47], s10 offen offset:3072 nt
s_branch L_q_w
L_q_w0:
v_and_b32 v28, 15, v1
v_lshlrev_b32 v28, 3, v28
ds_read_b64 v[32:33], v28 offset:7168
ds_read_b64 v[34:35], v28 offset:7296
ds_read_b64 v[36:37], v28 offset:7424
ds_read_b64 v[38:39], v28 offset:7552
ds_read_b64 v[40:41], v28 offset:7680
ds_read_b64 v[42:43], v28 offset:7808
ds_read_b64 v[44:45], v28 offset:7936
ds_read_b64 v[46:47], v28 offset:8064
s_waitcnt lgkmcnt(0)
v_add_f32 v32, v32, v34
v_add_f32 v33, v33, v35
v_add_f32 v32, v32, v36
v_add_f32 v33, v33, v37
v_add_f32 v32, v32, v38
v_add_f32 v33, v33, v39
v_add_f32 v32, v32, v40
v_add_f32 v33, v33, v41
v_add_f32 v32, v32, v42
v_add_f32 v33, v33, v43
v_add_f32 v32, v32, v44
v_add_f32 v33, v33, v45
v_add_f32 v32, v32, v46
v_add_f32 v33, v33, v47
v_cvt_pk_bf16_f32 v32, v32, v33
s_cmp_eq_u32 s86, 0
s_cbranch_scc0 L_q_fallback
v_readfirstlane_b32 s9, v122
s_nop 3
s_cmp_eq_u32 s9, 0
s_cselect_b32 s16, s16, s9
v_mov_b32 v33, s16
v_mov_b32 v29, 0
ds_write_b32 v29, v33 offset:5900
s_lshl_b32 s9, s7, 10
s_lshl_b32 s10, s5, 7
s_add_u32 s10, s10, s9
s_add_u32 s10, s10, 0x0
s_add_u32 s9, s9, 0x0
s_mov_b64 exec, 0xffff
buffer_store_dwordx2 v[32:33], v28, s[76:79], s10 offen sc1
s_mov_b64 exec, -1
s_mov_b32 s85, s9
s_add_u32 s10, s21, 4096
buffer_load_dwordx4 v[192:195], v3, s[44:47], s21 offen offset:0 nt
buffer_load_dwordx4 v[196:199], v3, s[44:47], s21 offen offset:1024 nt
buffer_load_dwordx4 v[200:203], v3, s[44:47], s21 offen offset:2048 nt
buffer_load_dwordx4 v[204:207], v3, s[44:47], s21 offen offset:3072 nt
buffer_load_dwordx4 v[208:211], v3, s[44:47], s10 offen offset:0 nt
buffer_load_dwordx4 v[212:215], v3, s[44:47], s10 offen offset:1024 nt
buffer_load_dwordx4 v[216:219], v3, s[44:47], s10 offen offset:2048 nt
buffer_load_dwordx4 v[220:223], v3, s[44:47], s10 offen offset:3072 nt
s_mov_b32 s9, s85
s_mov_b32 s87, 0
L_qpoll:
buffer_load_dwordx4 v[32:35], v3, s[76:79], s9 offen sc1
s_waitcnt vmcnt(0)
v_cmp_eq_u32 vcc, s16, v33
v_cmp_eq_u32 s[80:81], s16, v35
s_nop 3
s_and_b64 vcc, vcc, s[80:81]
s_cmp_eq_u64 vcc, -1
s_cbranch_scc1 L_qgot
s_sleep 8
s_add_u32 s87, s87, 1
s_cmp_lt_u32 s87, 20000
s_cbranch_scc1 L_qpoll
v_mov_b32 v28, 1
v_mov_b32 v29, 0
ds_write_b32 v29, v28 offset:5904
s_branch L_q_w
L_qgot:
v_mov_b32 v33, v34
v_lshlrev_b32 v28, 3, v1
ds_write_b64 v28, v[32:33] offset:5376
v_mov_b32 v28, 0
ds_write_b32 v28, v28 offset:5904
s_branch L_q_w
L_q_fallback:
v_lshrrev_b32 v28, 1, v28
s_lshl_b32 s9, s84, 6
v_add_u32 v28, s9, v28
s_mov_b64 exec, 0xffff
ds_write_b32 v28, v32 offset:5376
s_mov_b64 exec, -1
L_q_w:
s_waitcnt lgkmcnt(0)
s_barrier
s_cmp_eq_u32 s86, 0
s_cbranch_scc0 L_q_m1
v_mov_b32 v28, 0
ds_read_b32 v28, v28 offset:5904
s_waitcnt lgkmcnt(0)
v_readfirstlane_b32 s9, v28
s_nop 3
s_cmp_eq_u32 s9, 0
s_cbranch_scc1 L_qdone
s_mov_b32 s86, 1
s_mov_b32 s84, 0
s_branch L_share_loop
L_q_m1:
s_add_u32 s84, s84, 1
s_cmp_lt_u32 s84, 8
s_cbranch_scc1 L_share_loop
L_qdone:
v_and_b32 v12, 31, v1
v_lshlrev_b32 v12, 4, v12
ds_read_b128 v[24:27], v12 offset:5376
v_mov_b32 v13, 0
ds_read_b32 v13, v13 offset:5900
s_waitcnt lgkmcnt(0)
v_readfirstlane_b32 s16, v13
s_add_u32 s10, s22, 4096
buffer_load_dwordx4 v[224:227], v3, s[44:47], s22 offen offset:0 nt
buffer_load_dwordx4 v[228:231], v3, s[44:47], s22 offen offset:1024 nt
buffer_load_dwordx4 v[232:235], v3, s[44:47], s22 offen offset:2048 nt
buffer_load_dwordx4 v[236:239], v3, s[44:47], s22 offen offset:3072 nt
buffer_load_dwordx4 v[240:243], v3, s[44:47], s10 offen offset:0 nt
buffer_load_dwordx4 v[244:247], v3, s[44:47], s10 offen offset:1024 nt
buffer_load_dwordx4 v[248:251], v3, s[44:47], s10 offen offset:2048 nt
buffer_load_dwordx4 v[252:255], v3, s[44:47], s10 offen offset:3072 nt
s_add_u32 s10, s23, 4096
buffer_load_dwordx4 v[64:67], v3, s[44:47], s23 offen offset:0 nt
buffer_load_dwordx4 v[68:71], v3, s[44:47], s23 offen offset:1024 nt
buffer_load_dwordx4 v[72:75], v3, s[44:47], s23 offen offset:2048 nt
buffer_load_dwordx4 v[76:79], v3, s[44:47], s23 offen offset:3072 nt
buffer_load_dwordx4 v[80:83], v3, s[44:47], s10 offen offset:0 nt
buffer_load_dwordx4 v[84:87], v3, s[44:47], s10 offen offset:1024 nt
buffer_load_dwordx4 v[88:91], v3, s[44:47], s10 offen offset:2048 nt
buffer_load_dwordx4 v[92:95], v3, s[44:47], s10 offen offset:3072 nt
s_waitcnt lgkmcnt(0)
s_barrier
s_waitcnt vmcnt(24)
v_dot2_f32_bf16 v4, v160, v24, 0
v_dot2_f32_bf16 v5, v164, v24, 0
v_dot2_f32_bf16 v6, v168, v24, 0
v_dot2_f32_bf16 v7, v172, v24, 0
v_dot2_f32_bf16 v8, v176, v24, 0
v_dot2_f32_bf16 v9, v180, v24, 0
v_dot2_f32_bf16 v10, v184, v24, 0
v_dot2_f32_bf16 v11, v188, v24, 0
v_dot2_f32_bf16 v4, v161, v25, v4
v_dot2_f32_bf16 v5, v165, v25, v5
v_dot2_f32_bf16 v6, v169, v25, v6
v_dot2_f32_bf16 v7, v173, v25, v7
v_dot2_f32_bf16 v8, v177, v25, v8
v_dot2_f32_bf16 v9, v181, v25, v9
v_dot2_f32_bf16 v10, v185, v25, v10
v_dot2_f32_bf16 v11, v189, v25, v11
v_dot2_f32_bf16 v4, v162, v26, v4
v_dot2_f32_bf16 v5, v166, v26, v5
v_dot2_f32_bf16 v6, v170, v26, v6
v_dot2_f32_bf16 v7, v174, v26, v7
v_dot2_f32_bf16 v8, v178, v26, v8
v_dot2_f32_bf16 v9, v182, v26, v9
v_dot2_f32_bf16 v10, v186, v26, v10
v_dot2_f32_bf16 v11, v190, v26, v11
v_dot2_f32_bf16 v4, v163, v27, v4
v_dot2_f32_bf16 v5, v167, v27, v5
v_dot2_f32_bf16 v6, v171, v27, v6
v_dot2_f32_bf16 v7, v175, v27, v7
v_dot2_f32_bf16 v8, v179, v27, v8
v_dot2_f32_bf16 v9, v183, v27, v9
v_dot2_f32_bf16 v10, v187, v27, v10
v_dot2_f32_bf16 v11, v191, v27, v11
s_add_u32 s10, s24, 4096
buffer_load_dwordx4 v[96:99], v3, s[44:47], s24 offen offset:0 nt
buffer_load_dwordx4 v[100:103], v3, s[44:47], s24 offen offset:1024 nt
buffer_load_dwordx4 v[104:107], v3, s[44:47], s24 offen offset:2048 nt
buffer_load_dwordx4 v[108:111], v3, s[44:47], s24 offen offset:3072 nt
buffer_load_dwordx4 v[112:115], v3, s[44:47], s10 offen offset:0 nt
buffer_load_dwordx4 v[116:119], v3, s[44:47], s10 offen offset:1024 nt
buffer_load_dwordx4 v[120:123], v3, s[44:47], s10 offen offset:2048 nt
buffer_load_dwordx4 v[124:127], v3, s[44:47], s10 offen offset:3072 nt
s_nop 3
v_permlane16_swap_b32 v4, v5
v_permlane16_swap_b32 v6, v7
v_permlane16_swap_b32 v8, v9
v_permlane16_swap_b32 v10, v11
s_nop 0
v_add_f32 v12, v4, v5
v_add_f32 v13, v6, v7
v_add_f32 v14, v8, v9
v_add_f32 v15, v10, v11
s_nop 0
v_add_f32_dpp v12, v12, v12 row_ror:8 row_mask:0xf bank_mask:0xf
v_add_f32_dpp v13, v13, v13 row_ror:8 row_mask:0xf bank_mask:0xf
v_add_f32_dpp v14, v14, v14 row_ror:8 row_mask:0xf bank_mask:0xf
v_add_f32_dpp v15, v15, v15 row_ror:8 row_mask:0xf bank_mask:0xf
s_nop 0
v_add_f32_dpp v12, v12, v12 row_ror:4 row_mask:0xf bank_mask:0xf
v_add_f32_dpp v13, v13, v13 row_ror:4 row_mask:0xf bank_mask:0xf
v_add_f32_dpp v14, v14, v14 row_ror:4 row_mask:0xf bank_mask:0xf
v_add_f32_dpp v15, v15, v15 row_ror:4 row_mask:0xf bank_mask:0xf
s_nop 0
v_add_f32_dpp v12, v12, v12 row_ror:2 row_mask:0xf bank_mask:0xf
v_add_f32_dpp v13, v13, v13 row_ror:2 row_mask:0xf bank_mask:0xf
v_add_f32_dpp v14, v14, v14 row_ror:2 row_mask:0xf bank_mask:0xf
v_add_f32_dpp v15, v15, v15 row_ror:2 row_mask:0xf bank_mask:0xf
s_nop 0
v_add_f32_dpp v12, v12, v12 row_ror:1 row_mask:0xf bank_mask:0xf
v_add_f32_dpp v13, v13, v13 row_ror:1 row_mask:0xf bank_mask:0xf
v_add_f32_dpp v14, v14, v14 row_ror:1 row_mask:0xf bank_mask:0xf
v_add_f32_dpp v15, v15, v15 row_ror:1 row_mask:0xf bank_mask:0xf
v_cvt_pk_bf16_f32 v32, 0, v12
v_cvt_pk_bf16_f32 v33, 0, v13
v_cvt_pk_bf16_f32 v34, 0, v14
v_cvt_pk_bf16_f32 v35, 0, v15
s_barrier
s_waitcnt vmcnt(24)
v_dot2_f32_bf16 v4, v192, v24, 0
v_dot2_f32_bf16 v5, v196, v24, 0
v_dot2_f32_bf16 v6, v200, v24, 0
v_dot2_f32_bf16 v7, v204, v24, 0
v_dot2_f32_bf16 v8, v208, v24, 0
v_dot2_f32_bf16 v9, v212, v24, 0
v_dot2_f32_bf16 v10, v216, v24, 0
v_dot2_f32_bf16 v11, v220, v24, 0
v_dot2_f32_bf16 v4, v193, v25, v4
v_dot2_f32_bf16 v5, v197, v25, v5
v_dot2_f32_bf16 v6, v201, v25, v6
v_dot2_f32_bf16 v7, v205, v25, v7
v_dot2_f32_bf16 v8, v209, v25, v8
v_dot2_f32_bf16 v9, v213, v25, v9
v_dot2_f32_bf16 v10, v217, v25, v10
v_dot2_f32_bf16 v11, v221, v25, v11
v_dot2_f32_bf16 v4, v194, v26, v4
v_dot2_f32_bf16 v5, v198, v26, v5
v_dot2_f32_bf16 v6, v202, v26, v6
v_dot2_f32_bf16 v7, v206, v26, v7
v_dot2_f32_bf16 v8, v210, v26, v8
v_dot2_f32_bf16 v9, v214, v26, v9
v_dot2_f32_bf16 v10, v218, v26, v10
v_dot2_f32_bf16 v11, v222, v26, v11
v_dot2_f32_bf16 v4, v195, v27, v4
v_dot2_f32_bf16 v5, v199, v27, v5
v_dot2_f32_bf16 v6, v203, v27, v6
v_dot2_f32_bf16 v7, v207, v27, v7
v_dot2_f32_bf16 v8, v211, v27, v8
v_dot2_f32_bf16 v9, v215, v27, v9
v_dot2_f32_bf16 v10, v219, v27, v10
v_dot2_f32_bf16 v11, v223, v27, v11
s_add_u32 s10, s25, 4096
buffer_load_dwordx4 v[128:131], v3, s[44:47], s25 offen offset:0 nt
buffer_load_dwordx4 v[132:135], v3, s[44:47], s25 offen offset:1024 nt
buffer_load_dwordx4 v[136:139], v3, s[44:47], s25 offen offset:2048 nt
buffer_load_dwordx4 v[140:143], v3, s[44:47], s25 offen offset:3072 nt
buffer_load_dwordx4 v[144:147], v3, s[44:47], s10 offen offset:0 nt
buffer_load_dwordx4 v[148:151], v3, s[44:47], s10 offen offset:1024 nt
buffer_load_dwordx4 v[152:155], v3, s[44:47], s10 offen offset:2048 nt
buffer_load_dwordx4 v[156:159], v3, s[44:47], s10 offen offset:3072 nt
s_nop 3
v_permlane16_swap_b32 v4, v5
v_permlane16_swap_b32 v6, v7
v_permlane16_swap_b32 v8, v9
v_permlane16_swap_b32 v10, v11
s_nop 0
v_add_f32 v12, v4, v5
v_add_f32 v13, v6, v7
v_add_f32 v14, v8, v9
v_add_f32 v15, v10, v11
s_nop 0
v_add_f32_dpp v12, v12, v12 row_ror:8 row_mask:0xf bank_mask:0xf
v_add_f32_dpp v13, v13, v13 row_ror:8 row_mask:0xf bank_mask:0xf
v_add_f32_dpp v14, v14, v14 row_ror:8 row_mask:0xf bank_mask:0xf
v_add_f32_dpp v15, v15, v15 row_ror:8 row_mask:0xf bank_mask:0xf
s_nop 0
v_add_f32_dpp v12, v12, v12 row_ror:4 row_mask:0xf bank_mask:0xf
v_add_f32_dpp v13, v13, v13 row_ror:4 row_mask:0xf bank_mask:0xf
v_add_f32_dpp v14, v14, v14 row_ror:4 row_mask:0xf bank_mask:0xf
v_add_f32_dpp v15, v15, v15 row_ror:4 row_mask:0xf bank_mask:0xf
s_nop 0
v_add_f32_dpp v12, v12, v12 row_ror:2 row_mask:0xf bank_mask:0xf
v_add_f32_dpp v13, v13, v13 row_ror:2 row_mask:0xf bank_mask:0xf
v_add_f32_dpp v14, v14, v14 row_ror:2 row_mask:0xf bank_mask:0xf
v_add_f32_dpp v15, v15, v15 row_ror:2 row_mask:0xf bank_mask:0xf
s_nop 0
v_add_f32_dpp v12, v12, v12 row_ror:1 row_mask:0xf bank_mask:0xf
v_add_f32_dpp v13, v13, v13 row_ror:1 row_mask:0xf bank_mask:0xf
v_add_f32_dpp v14, v14, v14 row_ror:1 row_mask:0xf bank_mask:0xf
v_add_f32_dpp v15, v15, v15 row_ror:1 row_mask:0xf bank_mask:0xf
v_cvt_pk_bf16_f32 v36, 0, v12
v_cvt_pk_bf16_f32 v37, 0, v13
v_cvt_pk_bf16_f32 v38, 0, v14
v_cvt_pk_bf16_f32 v39, 0, v15
s_barrier
s_waitcnt vmcnt(24)
v_dot2_f32_bf16 v4, v224, v24, 0
v_dot2_f32_bf16 v5, v228, v24, 0
v_dot2_f32_bf16 v6, v232, v24, 0
v_dot2_f32_bf16 v7, v236, v24, 0
v_dot2_f32_bf16 v8, v240, v24, 0
v_dot2_f32_bf16 v9, v244, v24, 0
v_dot2_f32_bf16 v10, v248, v24, 0
v_dot2_f32_bf16 v11, v252, v24, 0
v_dot2_f32_bf16 v4, v225, v25, v4
v_dot2_f32_bf16 v5, v229, v25, v5
v_dot2_f32_bf16 v6, v233, v25, v6
v_dot2_f32_bf16 v7, v237, v25, v7
v_dot2_f32_bf16 v8, v241, v25, v8
v_dot2_f32_bf16 v9, v245, v25, v9
v_dot2_f32_bf16 v10, v249, v25, v10
v_dot2_f32_bf16 v11, v253, v25, v11
v_dot2_f32_bf16 v4, v226, v26, v4
v_dot2_f32_bf16 v5, v230, v26, v5
v_dot2_f32_bf16 v6, v234, v26, v6
v_dot2_f32_bf16 v7, v238, v26, v7
v_dot2_f32_bf16 v8, v242, v26, v8
v_dot2_f32_bf16 v9, v246, v26, v9
v_dot2_f32_bf16 v10, v250, v26, v10
v_dot2_f32_bf16 v11, v254, v26, v11
v_dot2_f32_bf16 v4, v227, v27, v4
v_dot2_f32_bf16 v5, v231, v27, v5
v_dot2_f32_bf16 v6, v235, v27, v6
v_dot2_f32_bf16 v7, v239, v27, v7
v_dot2_f32_bf16 v8, v243, v27, v8
v_dot2_f32_bf16 v9, v247, v27, v9
v_dot2_f32_bf16 v10, v251, v27, v10
v_dot2_f32_bf16 v11, v255, v27, v11
s_add_u32 s10, s26, 4096
buffer_load_dwordx4 v[160:163], v3, s[44:47], s26 offen offset:0 nt
buffer_load_dwordx4 v[164:167], v3, s[44:47], s26 offen offset:1024 nt
buffer_load_dwordx4 v[168:171], v3, s[44:47], s26 offen offset:2048 nt
buffer_load_dwordx4 v[172:175], v3, s[44:47], s26 offen offset:3072 nt
buffer_load_dwordx4 v[176:179], v3, s[44:47], s10 offen offset:0 nt
buffer_load_dwordx4 v[180:183], v3, s[44:47], s10 offen offset:1024 nt
buffer_load_dwordx4 v[184:187], v3, s[44:47], s10 offen offset:2048 nt
buffer_load_dwordx4 v[188:191], v3, s[44:47], s10 offen offset:3072 nt
s_nop 3
v_permlane16_swap_b32 v4, v5
v_permlane16_swap_b32 v6, v7
v_permlane16_swap_b32 v8, v9
v_permlane16_swap_b32 v10, v11
s_nop 0
v_add_f32 v12, v4, v5
v_add_f32 v13, v6, v7
v_add_f32 v14, v8, v9
v_add_f32 v15, v10, v11
s_nop 0
v_add_f32_dpp v12, v12, v12 row_ror:8 row_mask:0xf bank_mask:0xf
v_add_f32_dpp v13, v13, v13 row_ror:8 row_mask:0xf bank_mask:0xf
v_add_f32_dpp v14, v14, v14 row_ror:8 row_mask:0xf bank_mask:0xf
v_add_f32_dpp v15, v15, v15 row_ror:8 row_mask:0xf bank_mask:0xf
s_nop 0
v_add_f32_dpp v12, v12, v12 row_ror:4 row_mask:0xf bank_mask:0xf
v_add_f32_dpp v13, v13, v13 row_ror:4 row_mask:0xf bank_mask:0xf
v_add_f32_dpp v14, v14, v14 row_ror:4 row_mask:0xf bank_mask:0xf
v_add_f32_dpp v15, v15, v15 row_ror:4 row_mask:0xf bank_mask:0xf
s_nop 0
v_add_f32_dpp v12, v12, v12 row_ror:2 row_mask:0xf bank_mask:0xf
v_add_f32_dpp v13, v13, v13 row_ror:2 row_mask:0xf bank_mask:0xf
v_add_f32_dpp v14, v14, v14 row_ror:2 row_mask:0xf bank_mask:0xf
v_add_f32_dpp v15, v15, v15 row_ror:2 row_mask:0xf bank_mask:0xf
s_nop 0
v_add_f32_dpp v12, v12, v12 row_ror:1 row_mask:0xf bank_mask:0xf
v_add_f32_dpp v13, v13, v13 row_ror:1 row_mask:0xf bank_mask:0xf
v_add_f32_dpp v14, v14, v14 row_ror:1 row_mask:0xf bank_mask:0xf
v_add_f32_dpp v15, v15, v15 row_ror:1 row_mask:0xf bank_mask:0xf
v_cvt_pk_bf16_f32 v40, 0, v12
v_cvt_pk_bf16_f32 v41, 0, v13
v_cvt_pk_bf16_f32 v42, 0, v14
v_cvt_pk_bf16_f32 v43, 0, v15
s_barrier
s_waitcnt vmcnt(24)
v_dot2_f32_bf16 v4, v64, v24, 0
v_dot2_f32_bf16 v5, v68, v24, 0
v_dot2_f32_bf16 v6, v72, v24, 0
v_dot2_f32_bf16 v7, v76, v24, 0
v_dot2_f32_bf16 v8, v80, v24, 0
v_dot2_f32_bf16 v9, v84, v24, 0
v_dot2_f32_bf16 v10, v88, v24, 0
v_dot2_f32_bf16 v11, v92, v24, 0
v_dot2_f32_bf16 v4, v65, v25, v4
v_dot2_f32_bf16 v5, v69, v25, v5
v_dot2_f32_bf16 v6, v73, v25, v6
v_dot2_f32_bf16 v7, v77, v25, v7
v_dot2_f32_bf16 v8, v81, v25, v8
v_dot2_f32_bf16 v9, v85, v25, v9
v_dot2_f32_bf16 v10, v89, v25, v10
v_dot2_f32_bf16 v11, v93, v25, v11
v_dot2_f32_bf16 v4, v66, v26, v4
v_dot2_f32_bf16 v5, v70, v26, v5
v_dot2_f32_bf16 v6, v74, v26, v6
v_dot2_f32_bf16 v7, v78, v26, v7
v_dot2_f32_bf16 v8, v82, v26, v8
v_dot2_f32_bf16 v9, v86, v26, v9
v_dot2_f32_bf16 v10, v90, v26, v10
v_dot2_f32_bf16 v11, v94, v26, v11
v_dot2_f32_bf16 v4, v67, v27, v4
v_dot2_f32_bf16 v5, v71, v27, v5
v_dot2_f32_bf16 v6, v75, v27, v6
v_dot2_f32_bf16 v7, v79, v27, v7
v_dot2_f32_bf16 v8, v83, v27, v8
v_dot2_f32_bf16 v9, v87, v27, v9
v_dot2_f32_bf16 v10, v91, v27, v10
v_dot2_f32_bf16 v11, v95, v27, v11
s_add_u32 s10, s27, 4096
buffer_load_dwordx4 v[192:195], v3, s[44:47], s27 offen offset:0 nt
buffer_load_dwordx4 v[196:199], v3, s[44:47], s27 offen offset:1024 nt
buffer_load_dwordx4 v[200:203], v3, s[44:47], s27 offen offset:2048 nt
buffer_load_dwordx4 v[204:207], v3, s[44:47], s27 offen offset:3072 nt
buffer_load_dwordx4 v[208:211], v3, s[44:47], s10 offen offset:0 nt
buffer_load_dwordx4 v[212:215], v3, s[44:47], s10 offen offset:1024 nt
buffer_load_dwordx4 v[216:219], v3, s[44:47], s10 offen offset:2048 nt
buffer_load_dwordx4 v[220:223], v3, s[44:47], s10 offen offset:3072 nt
s_nop 3
v_permlane16_swap_b32 v4, v5
v_permlane16_swap_b32 v6, v7
v_permlane16_swap_b32 v8, v9
v_permlane16_swap_b32 v10, v11
s_nop 0
v_add_f32 v12, v4, v5
v_add_f32 v13, v6, v7
v_add_f32 v14, v8, v9
v_add_f32 v15, v10, v11
s_nop 0
v_add_f32_dpp v12, v12, v12 row_ror:8 row_mask:0xf bank_mask:0xf
v_add_f32_dpp v13, v13, v13 row_ror:8 row_mask:0xf bank_mask:0xf
v_add_f32_dpp v14, v14, v14 row_ror:8 row_mask:0xf bank_mask:0xf
v_add_f32_dpp v15, v15, v15 row_ror:8 row_mask:0xf bank_mask:0xf
s_nop 0
v_add_f32_dpp v12, v12, v12 row_ror:4 row_mask:0xf bank_mask:0xf
v_add_f32_dpp v13, v13, v13 row_ror:4 row_mask:0xf bank_mask:0xf
v_add_f32_dpp v14, v14, v14 row_ror:4 row_mask:0xf bank_mask:0xf
v_add_f32_dpp v15, v15, v15 row_ror:4 row_mask:0xf bank_mask:0xf
s_nop 0
v_add_f32_dpp v12, v12, v12 row_ror:2 row_mask:0xf bank_mask:0xf
v_add_f32_dpp v13, v13, v13 row_ror:2 row_mask:0xf bank_mask:0xf
v_add_f32_dpp v14, v14, v14 row_ror:2 row_mask:0xf bank_mask:0xf
v_add_f32_dpp v15, v15, v15 row_ror:2 row_mask:0xf bank_mask:0xf
s_nop 0
v_add_f32_dpp v12, v12, v12 row_ror:1 row_mask:0xf bank_mask:0xf
v_add_f32_dpp v13, v13, v13 row_ror:1 row_mask:0xf bank_mask:0xf
v_add_f32_dpp v14, v14, v14 row_ror:1 row_mask:0xf bank_mask:0xf
v_add_f32_dpp v15, v15, v15 row_ror:1 row_mask:0xf bank_mask:0xf
v_cvt_pk_bf16_f32 v44, 0, v12
v_cvt_pk_bf16_f32 v45, 0, v13
v_cvt_pk_bf16_f32 v46, 0, v14
v_cvt_pk_bf16_f32 v47, 0, v15
s_barrier
s_waitcnt vmcnt(24)
v_dot2_f32_bf16 v4, v96, v24, 0
v_dot2_f32_bf16 v5, v100, v24, 0
v_dot2_f32_bf16 v6, v104, v24, 0
v_dot2_f32_bf16 v7, v108, v24, 0
v_dot2_f32_bf16 v8, v112, v24, 0
v_dot2_f32_bf16 v9, v116, v24, 0
v_dot2_f32_bf16 v10, v120, v24, 0
v_dot2_f32_bf16 v11, v124, v24, 0
v_dot2_f32_bf16 v4, v97, v25, v4
v_dot2_f32_bf16 v5, v101, v25, v5
v_dot2_f32_bf16 v6, v105, v25, v6
v_dot2_f32_bf16 v7, v109, v25, v7
v_dot2_f32_bf16 v8, v113, v25, v8
v_dot2_f32_bf16 v9, v117, v25, v9
v_dot2_f32_bf16 v10, v121, v25, v10
v_dot2_f32_bf16 v11, v125, v25, v11
v_dot2_f32_bf16 v4, v98, v26, v4
v_dot2_f32_bf16 v5, v102, v26, v5
v_dot2_f32_bf16 v6, v106, v26, v6
v_dot2_f32_bf16 v7, v110, v26, v7
v_dot2_f32_bf16 v8, v114, v26, v8
v_dot2_f32_bf16 v9, v118, v26, v9
v_dot2_f32_bf16 v10, v122, v26, v10
v_dot2_f32_bf16 v11, v126, v26, v11
v_dot2_f32_bf16 v4, v99, v27, v4
v_dot2_f32_bf16 v5, v103, v27, v5
v_dot2_f32_bf16 v6, v107, v27, v6
v_dot2_f32_bf16 v7, v111, v27, v7
v_dot2_f32_bf16 v8, v115, v27, v8
v_dot2_f32_bf16 v9, v119, v27, v9
v_dot2_f32_bf16 v10, v123, v27, v10
v_dot2_f32_bf16 v11, v127, v27, v11
s_add_u32 s10, s20, 4096
buffer_load_dwordx4 v[224:227], v3, s[48:51], s20 offen offset:0 nt
buffer_load_dwordx4 v[228:231], v3, s[48:51], s20 offen offset:1024 nt
buffer_load_dwordx4 v[232:235], v3, s[48:51], s20 offen offset:2048 nt
buffer_load_dwordx4 v[236:239], v3, s[48:51], s20 offen offset:3072 nt
buffer_load_dwordx4 v[240:243], v3, s[48:51], s10 offen offset:0 nt
buffer_load_dwordx4 v[244:247], v3, s[48:51], s10 offen offset:1024 nt
buffer_load_dwordx4 v[248:251], v3, s[48:51], s10 offen offset:2048 nt
buffer_load_dwordx4 v[252:255], v3, s[48:51], s10 offen offset:3072 nt
s_nop 3
v_permlane16_swap_b32 v4, v5
v_permlane16_swap_b32 v6, v7
v_permlane16_swap_b32 v8, v9
v_permlane16_swap_b32 v10, v11
s_nop 0
v_add_f32 v12, v4, v5
v_add_f32 v13, v6, v7
v_add_f32 v14, v8, v9
v_add_f32 v15, v10, v11
s_nop 0
v_add_f32_dpp v12, v12, v12 row_ror:8 row_mask:0xf bank_mask:0xf
v_add_f32_dpp v13, v13, v13 row_ror:8 row_mask:0xf bank_mask:0xf
v_add_f32_dpp v14, v14, v14 row_ror:8 row_mask:0xf bank_mask:0xf
v_add_f32_dpp v15, v15, v15 row_ror:8 row_mask:0xf bank_mask:0xf
s_nop 0
v_add_f32_dpp v12, v12, v12 row_ror:4 row_mask:0xf bank_mask:0xf
v_add_f32_dpp v13, v13, v13 row_ror:4 row_mask:0xf bank_mask:0xf
v_add_f32_dpp v14, v14, v14 row_ror:4 row_mask:0xf bank_mask:0xf
v_add_f32_dpp v15, v15, v15 row_ror:4 row_mask:0xf bank_mask:0xf
s_nop 0
v_add_f32_dpp v12, v12, v12 row_ror:2 row_mask:0xf bank_mask:0xf
v_add_f32_dpp v13, v13, v13 row_ror:2 row_mask:0xf bank_mask:0xf
v_add_f32_dpp v14, v14, v14 row_ror:2 row_mask:0xf bank_mask:0xf
v_add_f32_dpp v15, v15, v15 row_ror:2 row_mask:0xf bank_mask:0xf
s_nop 0
v_add_f32_dpp v12, v12, v12 row_ror:1 row_mask:0xf bank_mask:0xf
v_add_f32_dpp v13, v13, v13 row_ror:1 row_mask:0xf bank_mask:0xf
v_add_f32_dpp v14, v14, v14 row_ror:1 row_mask:0xf bank_mask:0xf
v_add_f32_dpp v15, v15, v15 row_ror:1 row_mask:0xf bank_mask:0xf
v_cvt_pk_bf16_f32 v48, 0, v12
v_cvt_pk_bf16_f32 v49, 0, v13
v_cvt_pk_bf16_f32 v50, 0, v14
v_cvt_pk_bf16_f32 v51, 0, v15
s_barrier
s_waitcnt vmcnt(24)
v_dot2_f32_bf16 v4, v128, v24, 0
v_dot2_f32_bf16 v5, v132, v24, 0
v_dot2_f32_bf16 v6, v136, v24, 0
v_dot2_f32_bf16 v7, v140, v24, 0
v_dot2_f32_bf16 v8, v144, v24, 0
v_dot2_f32_bf16 v9, v148, v24, 0
v_dot2_f32_bf16 v10, v152, v24, 0
v_dot2_f32_bf16 v11, v156, v24, 0
v_dot2_f32_bf16 v4, v129, v25, v4
v_dot2_f32_bf16 v5, v133, v25, v5
v_dot2_f32_bf16 v6, v137, v25, v6
v_dot2_f32_bf16 v7, v141, v25, v7
v_dot2_f32_bf16 v8, v145, v25, v8
v_dot2_f32_bf16 v9, v149, v25, v9
v_dot2_f32_bf16 v10, v153, v25, v10
v_dot2_f32_bf16 v11, v157, v25, v11
v_dot2_f32_bf16 v4, v130, v26, v4
v_dot2_f32_bf16 v5, v134, v26, v5
v_dot2_f32_bf16 v6, v138, v26, v6
v_dot2_f32_bf16 v7, v142, v26, v7
v_dot2_f32_bf16 v8, v146, v26, v8
v_dot2_f32_bf16 v9, v150, v26, v9
v_dot2_f32_bf16 v10, v154, v26, v10
v_dot2_f32_bf16 v11, v158, v26, v11
v_dot2_f32_bf16 v4, v131, v27, v4
v_dot2_f32_bf16 v5, v135, v27, v5
v_dot2_f32_bf16 v6, v139, v27, v6
v_dot2_f32_bf16 v7, v143, v27, v7
v_dot2_f32_bf16 v8, v147, v27, v8
v_dot2_f32_bf16 v9, v151, v27, v9
v_dot2_f32_bf16 v10, v155, v27, v10
v_dot2_f32_bf16 v11, v159, v27, v11
s_add_u32 s10, s21, 4096
buffer_load_dwordx4 v[64:67], v3, s[48:51], s21 offen offset:0 nt
buffer_load_dwordx4 v[68:71], v3, s[48:51], s21 offen offset:1024 nt
buffer_load_dwordx4 v[72:75], v3, s[48:51], s21 offen offset:2048 nt
buffer_load_dwordx4 v[76:79], v3, s[48:51], s21 offen offset:3072 nt
buffer_load_dwordx4 v[80:83], v3, s[48:51], s10 offen offset:0 nt
buffer_load_dwordx4 v[84:87], v3, s[48:51], s10 offen offset:1024 nt
buffer_load_dwordx4 v[88:91], v3, s[48:51], s10 offen offset:2048 nt
buffer_load_dwordx4 v[92:95], v3, s[48:51], s10 offen offset:3072 nt
s_nop 3
v_permlane16_swap_b32 v4, v5
v_permlane16_swap_b32 v6, v7
v_permlane16_swap_b32 v8, v9
v_permlane16_swap_b32 v10, v11
s_nop 0
v_add_f32 v12, v4, v5
v_add_f32 v13, v6, v7
v_add_f32 v14, v8, v9
v_add_f32 v15, v10, v11
s_nop 0
v_add_f32_dpp v12, v12, v12 row_ror:8 row_mask:0xf bank_mask:0xf
v_add_f32_dpp v13, v13, v13 row_ror:8 row_mask:0xf bank_mask:0xf
v_add_f32_dpp v14, v14, v14 row_ror:8 row_mask:0xf bank_mask:0xf
v_add_f32_dpp v15, v15, v15 row_ror:8 row_mask:0xf bank_mask:0xf
s_nop 0
v_add_f32_dpp v12, v12, v12 row_ror:4 row_mask:0xf bank_mask:0xf
v_add_f32_dpp v13, v13, v13 row_ror:4 row_mask:0xf bank_mask:0xf
v_add_f32_dpp v14, v14, v14 row_ror:4 row_mask:0xf bank_mask:0xf
v_add_f32_dpp v15, v15, v15 row_ror:4 row_mask:0xf bank_mask:0xf
s_nop 0
v_add_f32_dpp v12, v12, v12 row_ror:2 row_mask:0xf bank_mask:0xf
v_add_f32_dpp v13, v13, v13 row_ror:2 row_mask:0xf bank_mask:0xf
v_add_f32_dpp v14, v14, v14 row_ror:2 row_mask:0xf bank_mask:0xf
v_add_f32_dpp v15, v15, v15 row_ror:2 row_mask:0xf bank_mask:0xf
s_nop 0
v_add_f32_dpp v12, v12, v12 row_ror:1 row_mask:0xf bank_mask:0xf
v_add_f32_dpp v13, v13, v13 row_ror:1 row_mask:0xf bank_mask:0xf
v_add_f32_dpp v14, v14, v14 row_ror:1 row_mask:0xf bank_mask:0xf
v_add_f32_dpp v15, v15, v15 row_ror:1 row_mask:0xf bank_mask:0xf
v_cvt_pk_bf16_f32 v52, 0, v12
v_cvt_pk_bf16_f32 v53, 0, v13
v_cvt_pk_bf16_f32 v54, 0, v14
v_cvt_pk_bf16_f32 v55, 0, v15
s_barrier
s_waitcnt vmcnt(24)
v_dot2_f32_bf16 v4, v160, v24, 0
v_dot2_f32_bf16 v5, v164, v24, 0
v_dot2_f32_bf16 v6, v168, v24, 0
v_dot2_f32_bf16 v7, v172, v24, 0
v_dot2_f32_bf16 v8, v176, v24, 0
v_dot2_f32_bf16 v9, v180, v24, 0
v_dot2_f32_bf16 v10, v184, v24, 0
v_dot2_f32_bf16 v11, v188, v24, 0
v_dot2_f32_bf16 v4, v161, v25, v4
v_dot2_f32_bf16 v5, v165, v25, v5
v_dot2_f32_bf16 v6, v169, v25, v6
v_dot2_f32_bf16 v7, v173, v25, v7
v_dot2_f32_bf16 v8, v177, v25, v8
v_dot2_f32_bf16 v9, v181, v25, v9
v_dot2_f32_bf16 v10, v185, v25, v10
v_dot2_f32_bf16 v11, v189, v25, v11
v_dot2_f32_bf16 v4, v162, v26, v4
v_dot2_f32_bf16 v5, v166, v26, v5
v_dot2_f32_bf16 v6, v170, v26, v6
v_dot2_f32_bf16 v7, v174, v26, v7
v_dot2_f32_bf16 v8, v178, v26, v8
v_dot2_f32_bf16 v9, v182, v26, v9
v_dot2_f32_bf16 v10, v186, v26, v10
v_dot2_f32_bf16 v11, v190, v26, v11
v_dot2_f32_bf16 v4, v163, v27, v4
v_dot2_f32_bf16 v5, v167, v27, v5
v_dot2_f32_bf16 v6, v171, v27, v6
v_dot2_f32_bf16 v7, v175, v27, v7
v_dot2_f32_bf16 v8, v179, v27, v8
v_dot2_f32_bf16 v9, v183, v27, v9
v_dot2_f32_bf16 v10, v187, v27, v10
v_dot2_f32_bf16 v11, v191, v27, v11
s_add_u32 s10, s22, 4096
buffer_load_dwordx4 v[96:99], v3, s[48:51], s22 offen offset:0 nt
buffer_load_dwordx4 v[100:103], v3, s[48:51], s22 offen offset:1024 nt
buffer_load_dwordx4 v[104:107], v3, s[48:51], s22 offen offset:2048 nt
buffer_load_dwordx4 v[108:111], v3, s[48:51], s22 offen offset:3072 nt
buffer_load_dwordx4 v[112:115], v3, s[48:51], s10 offen offset:0 nt
buffer_load_dwordx4 v[116:119], v3, s[48:51], s10 offen offset:1024 nt
buffer_load_dwordx4 v[120:123], v3, s[48:51], s10 offen offset:2048 nt
buffer_load_dwordx4 v[124:127], v3, s[48:51], s10 offen offset:3072 nt
s_nop 3
v_permlane16_swap_b32 v4, v5
v_permlane16_swap_b32 v6, v7
v_permlane16_swap_b32 v8, v9
v_permlane16_swap_b32 v10, v11
s_nop 0
v_add_f32 v12, v4, v5
v_add_f32 v13, v6, v7
v_add_f32 v14, v8, v9
v_add_f32 v15, v10, v11
s_nop 0
v_add_f32_dpp v12, v12, v12 row_ror:8 row_mask:0xf bank_mask:0xf
v_add_f32_dpp v13, v13, v13 row_ror:8 row_mask:0xf bank_mask:0xf
v_add_f32_dpp v14, v14, v14 row_ror:8 row_mask:0xf bank_mask:0xf
v_add_f32_dpp v15, v15, v15 row_ror:8 row_mask:0xf bank_mask:0xf
s_nop 0
v_add_f32_dpp v12, v12, v12 row_ror:4 row_mask:0xf bank_mask:0xf
v_add_f32_dpp v13, v13, v13 row_ror:4 row_mask:0xf bank_mask:0xf
v_add_f32_dpp v14, v14, v14 row_ror:4 row_mask:0xf bank_mask:0xf
v_add_f32_dpp v15, v15, v15 row_ror:4 row_mask:0xf bank_mask:0xf
s_nop 0
v_add_f32_dpp v12, v12, v12 row_ror:2 row_mask:0xf bank_mask:0xf
v_add_f32_dpp v13, v13, v13 row_ror:2 row_mask:0xf bank_mask:0xf
v_add_f32_dpp v14, v14, v14 row_ror:2 row_mask:0xf bank_mask:0xf
v_add_f32_dpp v15, v15, v15 row_ror:2 row_mask:0xf bank_mask:0xf
s_nop 0
v_add_f32_dpp v12, v12, v12 row_ror:1 row_mask:0xf bank_mask:0xf
v_add_f32_dpp v13, v13, v13 row_ror:1 row_mask:0xf bank_mask:0xf
v_add_f32_dpp v14, v14, v14 row_ror:1 row_mask:0xf bank_mask:0xf
v_add_f32_dpp v15, v15, v15 row_ror:1 row_mask:0xf bank_mask:0xf
v_cvt_pk_bf16_f32 v56, 0, v12
v_cvt_pk_bf16_f32 v57, 0, v13
v_cvt_pk_bf16_f32 v58, 0, v14
v_cvt_pk_bf16_f32 v59, 0, v15
s_barrier
s_waitcnt vmcnt(24)
v_dot2_f32_bf16 v4, v192, v24, 0
v_dot2_f32_bf16 v5, v196, v24, 0
v_dot2_f32_bf16 v6, v200, v24, 0
v_dot2_f32_bf16 v7, v204, v24, 0
v_dot2_f32_bf16 v8, v208, v24, 0
v_dot2_f32_bf16 v9, v212, v24, 0
v_dot2_f32_bf16 v10, v216, v24, 0
v_dot2_f32_bf16 v11, v220, v24, 0
v_dot2_f32_bf16 v4, v193, v25, v4
v_dot2_f32_bf16 v5, v197, v25, v5
v_dot2_f32_bf16 v6, v201, v25, v6
v_dot2_f32_bf16 v7, v205, v25, v7
v_dot2_f32_bf16 v8, v209, v25, v8
v_dot2_f32_bf16 v9, v213, v25, v9
v_dot2_f32_bf16 v10, v217, v25, v10
v_dot2_f32_bf16 v11, v221, v25, v11
v_dot2_f32_bf16 v4, v194, v26, v4
v_dot2_f32_bf16 v5, v198, v26, v5
v_dot2_f32_bf16 v6, v202, v26, v6
v_dot2_f32_bf16 v7, v206, v26, v7
v_dot2_f32_bf16 v8, v210, v26, v8
v_dot2_f32_bf16 v9, v214, v26, v9
v_dot2_f32_bf16 v10, v218, v26, v10
v_dot2_f32_bf16 v11, v222, v26, v11
v_dot2_f32_bf16 v4, v195, v27, v4
v_dot2_f32_bf16 v5, v199, v27, v5
v_dot2_f32_bf16 v6, v203, v27, v6
v_dot2_f32_bf16 v7, v207, v27, v7
v_dot2_f32_bf16 v8, v211, v27, v8
v_dot2_f32_bf16 v9, v215, v27, v9
v_dot2_f32_bf16 v10, v219, v27, v10
v_dot2_f32_bf16 v11, v223, v27, v11
s_add_u32 s10, s23, 4096
buffer_load_dwordx4 v[128:131], v3, s[48:51], s23 offen offset:0 nt
buffer_load_dwordx4 v[132:135], v3, s[48:51], s23 offen offset:1024 nt
buffer_load_dwordx4 v[136:139], v3, s[48:51], s23 offen offset:2048 nt
buffer_load_dwordx4 v[140:143], v3, s[48:51], s23 offen offset:3072 nt
buffer_load_dwordx4 v[144:147], v3, s[48:51], s10 offen offset:0 nt
buffer_load_dwordx4 v[148:151], v3, s[48:51], s10 offen offset:1024 nt
buffer_load_dwordx4 v[152:155], v3, s[48:51], s10 offen offset:2048 nt
buffer_load_dwordx4 v[156:159], v3, s[48:51], s10 offen offset:3072 nt
s_nop 3
v_permlane16_swap_b32 v4, v5
v_permlane16_swap_b32 v6, v7
v_permlane16_swap_b32 v8, v9
v_permlane16_swap_b32 v10, v11
s_nop 0
v_add_f32 v12, v4, v5
v_add_f32 v13, v6, v7
v_add_f32 v14, v8, v9
v_add_f32 v15, v10, v11
s_nop 0
v_add_f32_dpp v12, v12, v12 row_ror:8 row_mask:0xf bank_mask:0xf
v_add_f32_dpp v13, v13, v13 row_ror:8 row_mask:0xf bank_mask:0xf
v_add_f32_dpp v14, v14, v14 row_ror:8 row_mask:0xf bank_mask:0xf
v_add_f32_dpp v15, v15, v15 row_ror:8 row_mask:0xf bank_mask:0xf
s_nop 0
v_add_f32_dpp v12, v12, v12 row_ror:4 row_mask:0xf bank_mask:0xf
v_add_f32_dpp v13, v13, v13 row_ror:4 row_mask:0xf bank_mask:0xf
v_add_f32_dpp v14, v14, v14 row_ror:4 row_mask:0xf bank_mask:0xf
v_add_f32_dpp v15, v15, v15 row_ror:4 row_mask:0xf bank_mask:0xf
s_nop 0
v_add_f32_dpp v12, v12, v12 row_ror:2 row_mask:0xf bank_mask:0xf
v_add_f32_dpp v13, v13, v13 row_ror:2 row_mask:0xf bank_mask:0xf
v_add_f32_dpp v14, v14, v14 row_ror:2 row_mask:0xf bank_mask:0xf
v_add_f32_dpp v15, v15, v15 row_ror:2 row_mask:0xf bank_mask:0xf
s_nop 0
v_add_f32_dpp v12, v12, v12 row_ror:1 row_mask:0xf bank_mask:0xf
v_add_f32_dpp v13, v13, v13 row_ror:1 row_mask:0xf bank_mask:0xf
v_add_f32_dpp v14, v14, v14 row_ror:1 row_mask:0xf bank_mask:0xf
v_add_f32_dpp v15, v15, v15 row_ror:1 row_mask:0xf bank_mask:0xf
v_cvt_pk_bf16_f32 v60, 0, v12
v_cvt_pk_bf16_f32 v61, 0, v13
v_cvt_pk_bf16_f32 v62, 0, v14
v_cvt_pk_bf16_f32 v63, 0, v15
v_max3_f32 v30, v32, v33, v34
v_max3_f32 v30, v30, v35, v36
v_max3_f32 v30, v30, v37, v38
v_max3_f32 v30, v30, v39, v40
v_max3_f32 v30, v30, v41, v42
v_max3_f32 v30, v30, v43, v44
v_max3_f32 v30, v30, v45, v46
v_max3_f32 v30, v30, v47, v48
v_max3_f32 v30, v30, v49, v50
v_max3_f32 v30, v30, v51, v52
v_max3_f32 v30, v30, v53, v54
v_max3_f32 v30, v30, v55, v56
v_max3_f32 v30, v30, v57, v58
v_max3_f32 v30, v30, v59, v60
v_max3_f32 v30, v30, v61, v62
v_max_f32 v30, v30, v63
v_mov_b32 v12, v30
s_nop 1
v_permlane16_swap_b32 v30, v12
s_nop 0
v_max_f32 v30, v30, v12
v_mov_b32 v12, v30
s_nop 1
v_permlane32_swap_b32 v30, v12
s_nop 0
v_max_f32 v30, v30, v12
v_sub_f32 v12, v32, v30
v_mul_f32 v12, s13, v12
v_exp_f32 v32, v12
v_sub_f32 v12, v33, v30
v_mul_f32 v12, s13, v12
v_exp_f32 v33, v12
v_sub_f32 v12, v34, v30
v_mul_f32 v12, s13, v12
v_exp_f32 v34, v12
v_sub_f32 v12, v35, v30
v_mul_f32 v12, s13, v12
v_exp_f32 v35, v12
v_sub_f32 v12, v36, v30
v_mul_f32 v12, s13, v12
v_exp_f32 v36, v12
v_sub_f32 v12, v37, v30
v_mul_f32 v12, s13, v12
v_exp_f32 v37, v12
v_sub_f32 v12, v38, v30
v_mul_f32 v12, s13, v12
v_exp_f32 v38, v12
v_sub_f32 v12, v39, v30
v_mul_f32 v12, s13, v12
v_exp_f32 v39, v12
v_sub_f32 v12, v40, v30
v_mul_f32 v12, s13, v12
v_exp_f32 v40, v12
v_sub_f32 v12, v41, v30
v_mul_f32 v12, s13, v12
v_exp_f32 v41, v12
v_sub_f32 v12, v42, v30
v_mul_f32 v12, s13, v12
v_exp_f32 v42, v12
v_sub_f32 v12, v43, v30
v_mul_f32 v12, s13, v12
v_exp_f32 v43, v12
v_sub_f32 v12, v44, v30
v_mul_f32 v12, s13, v12
v_exp_f32 v44, v12
v_sub_f32 v12, v45, v30
v_mul_f32 v12, s13, v12
v_exp_f32 v45, v12
v_sub_f32 v12, v46, v30
v_mul_f32 v12, s13, v12
v_exp_f32 v46, v12
v_sub_f32 v12, v47, v30
v_mul_f32 v12, s13, v12
v_exp_f32 v47, v12
v_sub_f32 v12, v48, v30
v_mul_f32 v12, s13, v12
v_exp_f32 v48, v12
v_sub_f32 v12, v49, v30
v_mul_f32 v12, s13, v12
v_exp_f32 v49, v12
v_sub_f32 v12, v50, v30
v_mul_f32 v12, s13, v12
v_exp_f32 v50, v12
v_sub_f32 v12, v51, v30
v_mul_f32 v12, s13, v12
v_exp_f32 v51, v12
v_sub_f32 v12, v52, v30
v_mul_f32 v12, s13, v12
v_exp_f32 v52, v12
v_sub_f32 v12, v53, v30
v_mul_f32 v12, s13, v12
v_exp_f32 v53, v12
v_sub_f32 v12, v54, v30
v_mul_f32 v12, s13, v12
v_exp_f32 v54, v12
v_sub_f32 v12, v55, v30
v_mul_f32 v12, s13, v12
v_exp_f32 v55, v12
v_sub_f32 v12, v56, v30
v_mul_f32 v12, s13, v12
v_exp_f32 v56, v12
v_sub_f32 v12, v57, v30
v_mul_f32 v12, s13, v12
v_exp_f32 v57, v12
v_sub_f32 v12, v58, v30
v_mul_f32 v12, s13, v12
v_exp_f32 v58, v12
v_sub_f32 v12, v59, v30
v_mul_f32 v12, s13, v12
v_exp_f32 v59, v12
v_sub_f32 v12, v60, v30
v_mul_f32 v12, s13, v12
v_exp_f32 v60, v12
v_sub_f32 v12, v61, v30
v_mul_f32 v12, s13, v12
v_exp_f32 v61, v12
v_sub_f32 v12, v62, v30
v_mul_f32 v12, s13, v12
v_exp_f32 v62, v12
v_sub_f32 v12, v63, v30
v_mul_f32 v12, s13, v12
v_exp_f32 v63, v12
s_nop 0
v_add_f32 v31, v32, v33
v_add_f32 v31, v31, v34
v_add_f32 v31, v31, v35
v_add_f32 v31, v31, v36
v_add_f32 v31, v31, v37
v_add_f32 v31, v31, v38
v_add_f32 v31, v31, v39
v_add_f32 v31, v31, v40
v_add_f32 v31, v31, v41
v_add_f32 v31, v31, v42
v_add_f32 v31, v31, v43
v_add_f32 v31, v31, v44
v_add_f32 v31, v31, v45
v_add_f32 v31, v31, v46
v_add_f32 v31, v31, v47
v_add_f32 v31, v31, v48
v_add_f32 v31, v31, v49
v_add_f32 v31, v31, v50
v_add_f32 v31, v31, v51
v_add_f32 v31, v31, v52
v_add_f32 v31, v31, v53
v_add_f32 v31, v31, v54
v_add_f32 v31, v31, v55
v_add_f32 v31, v31, v56
v_add_f32 v31, v31, v57
v_add_f32 v31, v31, v58
v_add_f32 v31, v31, v59
v_add_f32 v31, v31, v60
v_add_f32 v31, v31, v61
v_add_f32 v31, v31, v62
v_add_f32 v31, v31, v63
v_mov_b32 v12, v31
s_nop 1
v_permlane16_swap_b32 v31, v12
s_nop 0
v_add_f32 v31, v31, v12
v_mov_b32 v12, v31
s_nop 1
v_permlane32_swap_b32 v31, v12
s_nop 0
v_add_f32 v31, v31, v12
v_lshrrev_b32 v12, 5, v1
v_lshlrev_b32 v12, 5, v12
v_bfe_u32 v13, v1, 4, 1
v_lshl_add_u32 v12, v13, 2, v12
s_lshl_b32 s15, s6, 9
v_add_u32 v12, s15, v12
s_mov_b32 exec_lo, 0x00010001
s_mov_b32 exec_hi, 0x00010001
ds_write_b32 v12, v32 offset:8192
ds_write_b32 v12, v33 offset:8200
ds_write_b32 v12, v34 offset:8208
ds_write_b32 v12, v35 offset:8216
ds_write_b32 v12, v36 offset:8256
ds_write_b32 v12, v37 offset:8264
ds_write_b32 v12, v38 offset:8272
ds_write_b32 v12, v39 offset:8280
ds_write_b32 v12, v40 offset:8320
ds_write_b32 v12, v41 offset:8328
ds_write_b32 v12, v42 offset:8336
ds_write_b32 v12, v43 offset:8344
ds_write_b32 v12, v44 offset:8384
ds_write_b32 v12, v45 offset:8392
ds_write_b32 v12, v46 offset:8400
ds_write_b32 v12, v47 offset:8408
ds_write_b32 v12, v48 offset:8448
ds_write_b32 v12, v49 offset:8456
ds_write_b32 v12, v50 offset:8464
ds_write_b32 v12, v51 offset:8472
ds_write_b32 v12, v52 offset:8512
ds_write_b32 v12, v53 offset:8520
ds_write_b32 v12, v54 offset:8528
ds_write_b32 v12, v55 offset:8536
ds_write_b32 v12, v56 offset:8576
ds_write_b32 v12, v57 offset:8584
ds_write_b32 v12, v58 offset:8592
ds_write_b32 v12, v59 offset:8600
ds_write_b32 v12, v60 offset:8640
ds_write_b32 v12, v61 offset:8648
ds_write_b32 v12, v62 offset:8656
ds_write_b32 v12, v63 offset:8664
s_mov_b64 exec, -1
v_lshrrev_b32 v29, 5, v1
v_lshlrev_b32 v29, 5, v29
v_add_u32 v29, s15, v29
v_mov_b32 v4, 0
v_mov_b32 v5, 0
v_mov_b32 v6, 0
v_mov_b32 v7, 0
v_mov_b32 v8, 0
v_mov_b32 v9, 0
v_mov_b32 v10, 0
v_mov_b32 v11, 0
s_waitcnt lgkmcnt(0)
ds_read_b128 v[12:15], v29 offset:8192
ds_read_b128 v[16:19], v29 offset:8208
s_waitcnt lgkmcnt(0)
ds_read_b128 v[20:23], v29 offset:8256
ds_read_b128 v[24:27], v29 offset:8272
s_barrier
s_waitcnt vmcnt(24)
v_lshlrev_b32 v28, 16, v224
v_fmac_f32 v4, v12, v28
v_and_b32 v28, s14, v224
v_fmac_f32 v5, v12, v28
v_lshlrev_b32 v28, 16, v225
v_fmac_f32 v6, v12, v28
v_and_b32 v28, s14, v225
v_fmac_f32 v7, v12, v28
v_lshlrev_b32 v28, 16, v226
v_fmac_f32 v8, v12, v28
v_and_b32 v28, s14, v226
v_fmac_f32 v9, v12, v28
v_lshlrev_b32 v28, 16, v227
v_fmac_f32 v10, v12, v28
v_and_b32 v28, s14, v227
v_fmac_f32 v11, v12, v28
v_lshlrev_b32 v28, 16, v228
v_fmac_f32 v4, v13, v28
v_and_b32 v28, s14, v228
v_fmac_f32 v5, v13, v28
v_lshlrev_b32 v28, 16, v229
v_fmac_f32 v6, v13, v28
v_and_b32 v28, s14, v229
v_fmac_f32 v7, v13, v28
v_lshlrev_b32 v28, 16, v230
v_fmac_f32 v8, v13, v28
v_and_b32 v28, s14, v230
v_fmac_f32 v9, v13, v28
v_lshlrev_b32 v28, 16, v231
v_fmac_f32 v10, v13, v28
v_and_b32 v28, s14, v231
v_fmac_f32 v11, v13, v28
v_lshlrev_b32 v28, 16, v232
v_fmac_f32 v4, v14, v28
v_and_b32 v28, s14, v232
v_fmac_f32 v5, v14, v28
v_lshlrev_b32 v28, 16, v233
v_fmac_f32 v6, v14, v28
v_and_b32 v28, s14, v233
v_fmac_f32 v7, v14, v28
v_lshlrev_b32 v28, 16, v234
v_fmac_f32 v8, v14, v28
v_and_b32 v28, s14, v234
v_fmac_f32 v9, v14, v28
v_lshlrev_b32 v28, 16, v235
v_fmac_f32 v10, v14, v28
v_and_b32 v28, s14, v235
v_fmac_f32 v11, v14, v28
v_lshlrev_b32 v28, 16, v236
v_fmac_f32 v4, v15, v28
v_and_b32 v28, s14, v236
v_fmac_f32 v5, v15, v28
v_lshlrev_b32 v28, 16, v237
v_fmac_f32 v6, v15, v28
v_and_b32 v28, s14, v237
v_fmac_f32 v7, v15, v28
v_lshlrev_b32 v28, 16, v238
v_fmac_f32 v8, v15, v28
v_and_b32 v28, s14, v238
v_fmac_f32 v9, v15, v28
v_lshlrev_b32 v28, 16, v239
v_fmac_f32 v10, v15, v28
v_and_b32 v28, s14, v239
v_fmac_f32 v11, v15, v28
v_lshlrev_b32 v28, 16, v240
v_fmac_f32 v4, v16, v28
v_and_b32 v28, s14, v240
v_fmac_f32 v5, v16, v28
v_lshlrev_b32 v28, 16, v241
v_fmac_f32 v6, v16, v28
v_and_b32 v28, s14, v241
v_fmac_f32 v7, v16, v28
v_lshlrev_b32 v28, 16, v242
v_fmac_f32 v8, v16, v28
v_and_b32 v28, s14, v242
v_fmac_f32 v9, v16, v28
v_lshlrev_b32 v28, 16, v243
v_fmac_f32 v10, v16, v28
v_and_b32 v28, s14, v243
v_fmac_f32 v11, v16, v28
v_lshlrev_b32 v28, 16, v244
v_fmac_f32 v4, v17, v28
v_and_b32 v28, s14, v244
v_fmac_f32 v5, v17, v28
v_lshlrev_b32 v28, 16, v245
v_fmac_f32 v6, v17, v28
v_and_b32 v28, s14, v245
v_fmac_f32 v7, v17, v28
v_lshlrev_b32 v28, 16, v246
v_fmac_f32 v8, v17, v28
v_and_b32 v28, s14, v246
v_fmac_f32 v9, v17, v28
v_lshlrev_b32 v28, 16, v247
v_fmac_f32 v10, v17, v28
v_and_b32 v28, s14, v247
v_fmac_f32 v11, v17, v28
v_lshlrev_b32 v28, 16, v248
v_fmac_f32 v4, v18, v28
v_and_b32 v28, s14, v248
v_fmac_f32 v5, v18, v28
v_lshlrev_b32 v28, 16, v249
v_fmac_f32 v6, v18, v28
v_and_b32 v28, s14, v249
v_fmac_f32 v7, v18, v28
v_lshlrev_b32 v28, 16, v250
v_fmac_f32 v8, v18, v28
v_and_b32 v28, s14, v250
v_fmac_f32 v9, v18, v28
v_lshlrev_b32 v28, 16, v251
v_fmac_f32 v10, v18, v28
v_and_b32 v28, s14, v251
v_fmac_f32 v11, v18, v28
v_lshlrev_b32 v28, 16, v252
v_fmac_f32 v4, v19, v28
v_and_b32 v28, s14, v252
v_fmac_f32 v5, v19, v28
v_lshlrev_b32 v28, 16, v253
v_fmac_f32 v6, v19, v28
v_and_b32 v28, s14, v253
v_fmac_f32 v7, v19, v28
v_lshlrev_b32 v28, 16, v254
v_fmac_f32 v8, v19, v28
v_and_b32 v28, s14, v254
v_fmac_f32 v9, v19, v28
v_lshlrev_b32 v28, 16, v255
v_fmac_f32 v10, v19, v28
v_and_b32 v28, s14, v255
v_fmac_f32 v11, v19, v28
s_add_u32 s10, s24, 4096
buffer_load_dwordx4 v[160:163], v3, s[48:51], s24 offen offset:0 nt
buffer_load_dwordx4 v[164:167], v3, s[48:51], s24 offen offset:1024 nt
buffer_load_dwordx4 v[168:171], v3, s[48:51], s24 offen offset:2048 nt
buffer_load_dwordx4 v[172:175], v3, s[48:51], s24 offen offset:3072 nt
buffer_load_dwordx4 v[176:179], v3, s[48:51], s10 offen offset:0 nt
buffer_load_dwordx4 v[180:183], v3, s[48:51], s10 offen offset:1024 nt
buffer_load_dwordx4 v[184:187], v3, s[48:51], s10 offen offset:2048 nt
buffer_load_dwordx4 v[188:191], v3, s[48:51], s10 offen offset:3072 nt
s_waitcnt lgkmcnt(0)
ds_read_b128 v[12:15], v29 offset:8320
ds_read_b128 v[16:19], v29 offset:8336
s_barrier
s_waitcnt vmcnt(24)
v_lshlrev_b32 v28, 16, v64
v_fmac_f32 v4, v20, v28
v_and_b32 v28, s14, v64
v_fmac_f32 v5, v20, v28
v_lshlrev_b32 v28, 16, v65
v_fmac_f32 v6, v20, v28
v_and_b32 v28, s14, v65
v_fmac_f32 v7, v20, v28
v_lshlrev_b32 v28, 16, v66
v_fmac_f32 v8, v20, v28
v_and_b32 v28, s14, v66
v_fmac_f32 v9, v20, v28
v_lshlrev_b32 v28, 16, v67
v_fmac_f32 v10, v20, v28
v_and_b32 v28, s14, v67
v_fmac_f32 v11, v20, v28
v_lshlrev_b32 v28, 16, v68
v_fmac_f32 v4, v21, v28
v_and_b32 v28, s14, v68
v_fmac_f32 v5, v21, v28
v_lshlrev_b32 v28, 16, v69
v_fmac_f32 v6, v21, v28
v_and_b32 v28, s14, v69
v_fmac_f32 v7, v21, v28
v_lshlrev_b32 v28, 16, v70
v_fmac_f32 v8, v21, v28
v_and_b32 v28, s14, v70
v_fmac_f32 v9, v21, v28
v_lshlrev_b32 v28, 16, v71
v_fmac_f32 v10, v21, v28
v_and_b32 v28, s14, v71
v_fmac_f32 v11, v21, v28
v_lshlrev_b32 v28, 16, v72
v_fmac_f32 v4, v22, v28
v_and_b32 v28, s14, v72
v_fmac_f32 v5, v22, v28
v_lshlrev_b32 v28, 16, v73
v_fmac_f32 v6, v22, v28
v_and_b32 v28, s14, v73
v_fmac_f32 v7, v22, v28
v_lshlrev_b32 v28, 16, v74
v_fmac_f32 v8, v22, v28
v_and_b32 v28, s14, v74
v_fmac_f32 v9, v22, v28
v_lshlrev_b32 v28, 16, v75
v_fmac_f32 v10, v22, v28
v_and_b32 v28, s14, v75
v_fmac_f32 v11, v22, v28
v_lshlrev_b32 v28, 16, v76
v_fmac_f32 v4, v23, v28
v_and_b32 v28, s14, v76
v_fmac_f32 v5, v23, v28
v_lshlrev_b32 v28, 16, v77
v_fmac_f32 v6, v23, v28
v_and_b32 v28, s14, v77
v_fmac_f32 v7, v23, v28
v_lshlrev_b32 v28, 16, v78
v_fmac_f32 v8, v23, v28
v_and_b32 v28, s14, v78
v_fmac_f32 v9, v23, v28
v_lshlrev_b32 v28, 16, v79
v_fmac_f32 v10, v23, v28
v_and_b32 v28, s14, v79
v_fmac_f32 v11, v23, v28
v_lshlrev_b32 v28, 16, v80
v_fmac_f32 v4, v24, v28
v_and_b32 v28, s14, v80
v_fmac_f32 v5, v24, v28
v_lshlrev_b32 v28, 16, v81
v_fmac_f32 v6, v24, v28
v_and_b32 v28, s14, v81
v_fmac_f32 v7, v24, v28
v_lshlrev_b32 v28, 16, v82
v_fmac_f32 v8, v24, v28
v_and_b32 v28, s14, v82
v_fmac_f32 v9, v24, v28
v_lshlrev_b32 v28, 16, v83
v_fmac_f32 v10, v24, v28
v_and_b32 v28, s14, v83
v_fmac_f32 v11, v24, v28
v_lshlrev_b32 v28, 16, v84
v_fmac_f32 v4, v25, v28
v_and_b32 v28, s14, v84
v_fmac_f32 v5, v25, v28
v_lshlrev_b32 v28, 16, v85
v_fmac_f32 v6, v25, v28
v_and_b32 v28, s14, v85
v_fmac_f32 v7, v25, v28
v_lshlrev_b32 v28, 16, v86
v_fmac_f32 v8, v25, v28
v_and_b32 v28, s14, v86
v_fmac_f32 v9, v25, v28
v_lshlrev_b32 v28, 16, v87
v_fmac_f32 v10, v25, v28
v_and_b32 v28, s14, v87
v_fmac_f32 v11, v25, v28
v_lshlrev_b32 v28, 16, v88
v_fmac_f32 v4, v26, v28
v_and_b32 v28, s14, v88
v_fmac_f32 v5, v26, v28
v_lshlrev_b32 v28, 16, v89
v_fmac_f32 v6, v26, v28
v_and_b32 v28, s14, v89
v_fmac_f32 v7, v26, v28
v_lshlrev_b32 v28, 16, v90
v_fmac_f32 v8, v26, v28
v_and_b32 v28, s14, v90
v_fmac_f32 v9, v26, v28
v_lshlrev_b32 v28, 16, v91
v_fmac_f32 v10, v26, v28
v_and_b32 v28, s14, v91
v_fmac_f32 v11, v26, v28
v_lshlrev_b32 v28, 16, v92
v_fmac_f32 v4, v27, v28
v_and_b32 v28, s14, v92
v_fmac_f32 v5, v27, v28
v_lshlrev_b32 v28, 16, v93
v_fmac_f32 v6, v27, v28
v_and_b32 v28, s14, v93
v_fmac_f32 v7, v27, v28
v_lshlrev_b32 v28, 16, v94
v_fmac_f32 v8, v27, v28
v_and_b32 v28, s14, v94
v_fmac_f32 v9, v27, v28
v_lshlrev_b32 v28, 16, v95
v_fmac_f32 v10, v27, v28
v_and_b32 v28, s14, v95
v_fmac_f32 v11, v27, v28
s_add_u32 s10, s25, 4096
buffer_load_dwordx4 v[192:195], v3, s[48:51], s25 offen offset:0 nt
buffer_load_dwordx4 v[196:199], v3, s[48:51], s25 offen offset:1024 nt
buffer_load_dwordx4 v[200:203], v3, s[48:51], s25 offen offset:2048 nt
buffer_load_dwordx4 v[204:207], v3, s[48:51], s25 offen offset:3072 nt
buffer_load_dwordx4 v[208:211], v3, s[48:51], s10 offen offset:0 nt
buffer_load_dwordx4 v[212:215], v3, s[48:51], s10 offen offset:1024 nt
buffer_load_dwordx4 v[216:219], v3, s[48:51], s10 offen offset:2048 nt
buffer_load_dwordx4 v[220:223], v3, s[48:51], s10 offen offset:3072 nt
s_waitcnt lgkmcnt(0)
ds_read_b128 v[20:23], v29 offset:8384
ds_read_b128 v[24:27], v29 offset:8400
s_barrier
s_waitcnt vmcnt(24)
v_lshlrev_b32 v28, 16, v96
v_fmac_f32 v4, v12, v28
v_and_b32 v28, s14, v96
v_fmac_f32 v5, v12, v28
v_lshlrev_b32 v28, 16, v97
v_fmac_f32 v6, v12, v28
v_and_b32 v28, s14, v97
v_fmac_f32 v7, v12, v28
v_lshlrev_b32 v28, 16, v98
v_fmac_f32 v8, v12, v28
v_and_b32 v28, s14, v98
v_fmac_f32 v9, v12, v28
v_lshlrev_b32 v28, 16, v99
v_fmac_f32 v10, v12, v28
v_and_b32 v28, s14, v99
v_fmac_f32 v11, v12, v28
v_lshlrev_b32 v28, 16, v100
v_fmac_f32 v4, v13, v28
v_and_b32 v28, s14, v100
v_fmac_f32 v5, v13, v28
v_lshlrev_b32 v28, 16, v101
v_fmac_f32 v6, v13, v28
v_and_b32 v28, s14, v101
v_fmac_f32 v7, v13, v28
v_lshlrev_b32 v28, 16, v102
v_fmac_f32 v8, v13, v28
v_and_b32 v28, s14, v102
v_fmac_f32 v9, v13, v28
v_lshlrev_b32 v28, 16, v103
v_fmac_f32 v10, v13, v28
v_and_b32 v28, s14, v103
v_fmac_f32 v11, v13, v28
v_lshlrev_b32 v28, 16, v104
v_fmac_f32 v4, v14, v28
v_and_b32 v28, s14, v104
v_fmac_f32 v5, v14, v28
v_lshlrev_b32 v28, 16, v105
v_fmac_f32 v6, v14, v28
v_and_b32 v28, s14, v105
v_fmac_f32 v7, v14, v28
v_lshlrev_b32 v28, 16, v106
v_fmac_f32 v8, v14, v28
v_and_b32 v28, s14, v106
v_fmac_f32 v9, v14, v28
v_lshlrev_b32 v28, 16, v107
v_fmac_f32 v10, v14, v28
v_and_b32 v28, s14, v107
v_fmac_f32 v11, v14, v28
v_lshlrev_b32 v28, 16, v108
v_fmac_f32 v4, v15, v28
v_and_b32 v28, s14, v108
v_fmac_f32 v5, v15, v28
v_lshlrev_b32 v28, 16, v109
v_fmac_f32 v6, v15, v28
v_and_b32 v28, s14, v109
v_fmac_f32 v7, v15, v28
v_lshlrev_b32 v28, 16, v110
v_fmac_f32 v8, v15, v28
v_and_b32 v28, s14, v110
v_fmac_f32 v9, v15, v28
v_lshlrev_b32 v28, 16, v111
v_fmac_f32 v10, v15, v28
v_and_b32 v28, s14, v111
v_fmac_f32 v11, v15, v28
v_lshlrev_b32 v28, 16, v112
v_fmac_f32 v4, v16, v28
v_and_b32 v28, s14, v112
v_fmac_f32 v5, v16, v28
v_lshlrev_b32 v28, 16, v113
v_fmac_f32 v6, v16, v28
v_and_b32 v28, s14, v113
v_fmac_f32 v7, v16, v28
v_lshlrev_b32 v28, 16, v114
v_fmac_f32 v8, v16, v28
v_and_b32 v28, s14, v114
v_fmac_f32 v9, v16, v28
v_lshlrev_b32 v28, 16, v115
v_fmac_f32 v10, v16, v28
v_and_b32 v28, s14, v115
v_fmac_f32 v11, v16, v28
v_lshlrev_b32 v28, 16, v116
v_fmac_f32 v4, v17, v28
v_and_b32 v28, s14, v116
v_fmac_f32 v5, v17, v28
v_lshlrev_b32 v28, 16, v117
v_fmac_f32 v6, v17, v28
v_and_b32 v28, s14, v117
v_fmac_f32 v7, v17, v28
v_lshlrev_b32 v28, 16, v118
v_fmac_f32 v8, v17, v28
v_and_b32 v28, s14, v118
v_fmac_f32 v9, v17, v28
v_lshlrev_b32 v28, 16, v119
v_fmac_f32 v10, v17, v28
v_and_b32 v28, s14, v119
v_fmac_f32 v11, v17, v28
v_lshlrev_b32 v28, 16, v120
v_fmac_f32 v4, v18, v28
v_and_b32 v28, s14, v120
v_fmac_f32 v5, v18, v28
v_lshlrev_b32 v28, 16, v121
v_fmac_f32 v6, v18, v28
v_and_b32 v28, s14, v121
v_fmac_f32 v7, v18, v28
v_lshlrev_b32 v28, 16, v122
v_fmac_f32 v8, v18, v28
v_and_b32 v28, s14, v122
v_fmac_f32 v9, v18, v28
v_lshlrev_b32 v28, 16, v123
v_fmac_f32 v10, v18, v28
v_and_b32 v28, s14, v123
v_fmac_f32 v11, v18, v28
v_lshlrev_b32 v28, 16, v124
v_fmac_f32 v4, v19, v28
v_and_b32 v28, s14, v124
v_fmac_f32 v5, v19, v28
v_lshlrev_b32 v28, 16, v125
v_fmac_f32 v6, v19, v28
v_and_b32 v28, s14, v125
v_fmac_f32 v7, v19, v28
v_lshlrev_b32 v28, 16, v126
v_fmac_f32 v8, v19, v28
v_and_b32 v28, s14, v126
v_fmac_f32 v9, v19, v28
v_lshlrev_b32 v28, 16, v127
v_fmac_f32 v10, v19, v28
v_and_b32 v28, s14, v127
v_fmac_f32 v11, v19, v28
s_add_u32 s10, s26, 4096
buffer_load_dwordx4 v[224:227], v3, s[48:51], s26 offen offset:0 nt
buffer_load_dwordx4 v[228:231], v3, s[48:51], s26 offen offset:1024 nt
buffer_load_dwordx4 v[232:235], v3, s[48:51], s26 offen offset:2048 nt
buffer_load_dwordx4 v[236:239], v3, s[48:51], s26 offen offset:3072 nt
buffer_load_dwordx4 v[240:243], v3, s[48:51], s10 offen offset:0 nt
buffer_load_dwordx4 v[244:247], v3, s[48:51], s10 offen offset:1024 nt
buffer_load_dwordx4 v[248:251], v3, s[48:51], s10 offen offset:2048 nt
buffer_load_dwordx4 v[252:255], v3, s[48:51], s10 offen offset:3072 nt
s_waitcnt lgkmcnt(0)
ds_read_b128 v[12:15], v29 offset:8448
ds_read_b128 v[16:19], v29 offset:8464
s_barrier
s_waitcnt vmcnt(24)
v_lshlrev_b32 v28, 16, v128
v_fmac_f32 v4, v20, v28
v_and_b32 v28, s14, v128
v_fmac_f32 v5, v20, v28
v_lshlrev_b32 v28, 16, v129
v_fmac_f32 v6, v20, v28
v_and_b32 v28, s14, v129
v_fmac_f32 v7, v20, v28
v_lshlrev_b32 v28, 16, v130
v_fmac_f32 v8, v20, v28
v_and_b32 v28, s14, v130
v_fmac_f32 v9, v20, v28
v_lshlrev_b32 v28, 16, v131
v_fmac_f32 v10, v20, v28
v_and_b32 v28, s14, v131
v_fmac_f32 v11, v20, v28
v_lshlrev_b32 v28, 16, v132
v_fmac_f32 v4, v21, v28
v_and_b32 v28, s14, v132
v_fmac_f32 v5, v21, v28
v_lshlrev_b32 v28, 16, v133
v_fmac_f32 v6, v21, v28
v_and_b32 v28, s14, v133
v_fmac_f32 v7, v21, v28
v_lshlrev_b32 v28, 16, v134
v_fmac_f32 v8, v21, v28
v_and_b32 v28, s14, v134
v_fmac_f32 v9, v21, v28
v_lshlrev_b32 v28, 16, v135
v_fmac_f32 v10, v21, v28
v_and_b32 v28, s14, v135
v_fmac_f32 v11, v21, v28
v_lshlrev_b32 v28, 16, v136
v_fmac_f32 v4, v22, v28
v_and_b32 v28, s14, v136
v_fmac_f32 v5, v22, v28
v_lshlrev_b32 v28, 16, v137
v_fmac_f32 v6, v22, v28
v_and_b32 v28, s14, v137
v_fmac_f32 v7, v22, v28
v_lshlrev_b32 v28, 16, v138
v_fmac_f32 v8, v22, v28
v_and_b32 v28, s14, v138
v_fmac_f32 v9, v22, v28
v_lshlrev_b32 v28, 16, v139
v_fmac_f32 v10, v22, v28
v_and_b32 v28, s14, v139
v_fmac_f32 v11, v22, v28
v_lshlrev_b32 v28, 16, v140
v_fmac_f32 v4, v23, v28
v_and_b32 v28, s14, v140
v_fmac_f32 v5, v23, v28
v_lshlrev_b32 v28, 16, v141
v_fmac_f32 v6, v23, v28
v_and_b32 v28, s14, v141
v_fmac_f32 v7, v23, v28
v_lshlrev_b32 v28, 16, v142
v_fmac_f32 v8, v23, v28
v_and_b32 v28, s14, v142
v_fmac_f32 v9, v23, v28
v_lshlrev_b32 v28, 16, v143
v_fmac_f32 v10, v23, v28
v_and_b32 v28, s14, v143
v_fmac_f32 v11, v23, v28
v_lshlrev_b32 v28, 16, v144
v_fmac_f32 v4, v24, v28
v_and_b32 v28, s14, v144
v_fmac_f32 v5, v24, v28
v_lshlrev_b32 v28, 16, v145
v_fmac_f32 v6, v24, v28
v_and_b32 v28, s14, v145
v_fmac_f32 v7, v24, v28
v_lshlrev_b32 v28, 16, v146
v_fmac_f32 v8, v24, v28
v_and_b32 v28, s14, v146
v_fmac_f32 v9, v24, v28
v_lshlrev_b32 v28, 16, v147
v_fmac_f32 v10, v24, v28
v_and_b32 v28, s14, v147
v_fmac_f32 v11, v24, v28
v_lshlrev_b32 v28, 16, v148
v_fmac_f32 v4, v25, v28
v_and_b32 v28, s14, v148
v_fmac_f32 v5, v25, v28
v_lshlrev_b32 v28, 16, v149
v_fmac_f32 v6, v25, v28
v_and_b32 v28, s14, v149
v_fmac_f32 v7, v25, v28
v_lshlrev_b32 v28, 16, v150
v_fmac_f32 v8, v25, v28
v_and_b32 v28, s14, v150
v_fmac_f32 v9, v25, v28
v_lshlrev_b32 v28, 16, v151
v_fmac_f32 v10, v25, v28
v_and_b32 v28, s14, v151
v_fmac_f32 v11, v25, v28
v_lshlrev_b32 v28, 16, v152
v_fmac_f32 v4, v26, v28
v_and_b32 v28, s14, v152
v_fmac_f32 v5, v26, v28
v_lshlrev_b32 v28, 16, v153
v_fmac_f32 v6, v26, v28
v_and_b32 v28, s14, v153
v_fmac_f32 v7, v26, v28
v_lshlrev_b32 v28, 16, v154
v_fmac_f32 v8, v26, v28
v_and_b32 v28, s14, v154
v_fmac_f32 v9, v26, v28
v_lshlrev_b32 v28, 16, v155
v_fmac_f32 v10, v26, v28
v_and_b32 v28, s14, v155
v_fmac_f32 v11, v26, v28
v_lshlrev_b32 v28, 16, v156
v_fmac_f32 v4, v27, v28
v_and_b32 v28, s14, v156
v_fmac_f32 v5, v27, v28
v_lshlrev_b32 v28, 16, v157
v_fmac_f32 v6, v27, v28
v_and_b32 v28, s14, v157
v_fmac_f32 v7, v27, v28
v_lshlrev_b32 v28, 16, v158
v_fmac_f32 v8, v27, v28
v_and_b32 v28, s14, v158
v_fmac_f32 v9, v27, v28
v_lshlrev_b32 v28, 16, v159
v_fmac_f32 v10, v27, v28
v_and_b32 v28, s14, v159
v_fmac_f32 v11, v27, v28
s_add_u32 s10, s27, 4096
buffer_load_dwordx4 v[64:67], v3, s[48:51], s27 offen offset:0 nt
buffer_load_dwordx4 v[68:71], v3, s[48:51], s27 offen offset:1024 nt
buffer_load_dwordx4 v[72:75], v3, s[48:51], s27 offen offset:2048 nt
buffer_load_dwordx4 v[76:79], v3, s[48:51], s27 offen offset:3072 nt
buffer_load_dwordx4 v[80:83], v3, s[48:51], s10 offen offset:0 nt
buffer_load_dwordx4 v[84:87], v3, s[48:51], s10 offen offset:1024 nt
buffer_load_dwordx4 v[88:91], v3, s[48:51], s10 offen offset:2048 nt
buffer_load_dwordx4 v[92:95], v3, s[48:51], s10 offen offset:3072 nt
s_waitcnt lgkmcnt(0)
ds_read_b128 v[20:23], v29 offset:8512
ds_read_b128 v[24:27], v29 offset:8528
s_barrier
s_waitcnt vmcnt(24)
v_lshlrev_b32 v28, 16, v160
v_fmac_f32 v4, v12, v28
v_and_b32 v28, s14, v160
v_fmac_f32 v5, v12, v28
v_lshlrev_b32 v28, 16, v161
v_fmac_f32 v6, v12, v28
v_and_b32 v28, s14, v161
v_fmac_f32 v7, v12, v28
v_lshlrev_b32 v28, 16, v162
v_fmac_f32 v8, v12, v28
v_and_b32 v28, s14, v162
v_fmac_f32 v9, v12, v28
v_lshlrev_b32 v28, 16, v163
v_fmac_f32 v10, v12, v28
v_and_b32 v28, s14, v163
v_fmac_f32 v11, v12, v28
v_lshlrev_b32 v28, 16, v164
v_fmac_f32 v4, v13, v28
v_and_b32 v28, s14, v164
v_fmac_f32 v5, v13, v28
v_lshlrev_b32 v28, 16, v165
v_fmac_f32 v6, v13, v28
v_and_b32 v28, s14, v165
v_fmac_f32 v7, v13, v28
v_lshlrev_b32 v28, 16, v166
v_fmac_f32 v8, v13, v28
v_and_b32 v28, s14, v166
v_fmac_f32 v9, v13, v28
v_lshlrev_b32 v28, 16, v167
v_fmac_f32 v10, v13, v28
v_and_b32 v28, s14, v167
v_fmac_f32 v11, v13, v28
v_lshlrev_b32 v28, 16, v168
v_fmac_f32 v4, v14, v28
v_and_b32 v28, s14, v168
v_fmac_f32 v5, v14, v28
v_lshlrev_b32 v28, 16, v169
v_fmac_f32 v6, v14, v28
v_and_b32 v28, s14, v169
v_fmac_f32 v7, v14, v28
v_lshlrev_b32 v28, 16, v170
v_fmac_f32 v8, v14, v28
v_and_b32 v28, s14, v170
v_fmac_f32 v9, v14, v28
v_lshlrev_b32 v28, 16, v171
v_fmac_f32 v10, v14, v28
v_and_b32 v28, s14, v171
v_fmac_f32 v11, v14, v28
v_lshlrev_b32 v28, 16, v172
v_fmac_f32 v4, v15, v28
v_and_b32 v28, s14, v172
v_fmac_f32 v5, v15, v28
v_lshlrev_b32 v28, 16, v173
v_fmac_f32 v6, v15, v28
v_and_b32 v28, s14, v173
v_fmac_f32 v7, v15, v28
v_lshlrev_b32 v28, 16, v174
v_fmac_f32 v8, v15, v28
v_and_b32 v28, s14, v174
v_fmac_f32 v9, v15, v28
v_lshlrev_b32 v28, 16, v175
v_fmac_f32 v10, v15, v28
v_and_b32 v28, s14, v175
v_fmac_f32 v11, v15, v28
v_lshlrev_b32 v28, 16, v176
v_fmac_f32 v4, v16, v28
v_and_b32 v28, s14, v176
v_fmac_f32 v5, v16, v28
v_lshlrev_b32 v28, 16, v177
v_fmac_f32 v6, v16, v28
v_and_b32 v28, s14, v177
v_fmac_f32 v7, v16, v28
v_lshlrev_b32 v28, 16, v178
v_fmac_f32 v8, v16, v28
v_and_b32 v28, s14, v178
v_fmac_f32 v9, v16, v28
v_lshlrev_b32 v28, 16, v179
v_fmac_f32 v10, v16, v28
v_and_b32 v28, s14, v179
v_fmac_f32 v11, v16, v28
v_lshlrev_b32 v28, 16, v180
v_fmac_f32 v4, v17, v28
v_and_b32 v28, s14, v180
v_fmac_f32 v5, v17, v28
v_lshlrev_b32 v28, 16, v181
v_fmac_f32 v6, v17, v28
v_and_b32 v28, s14, v181
v_fmac_f32 v7, v17, v28
v_lshlrev_b32 v28, 16, v182
v_fmac_f32 v8, v17, v28
v_and_b32 v28, s14, v182
v_fmac_f32 v9, v17, v28
v_lshlrev_b32 v28, 16, v183
v_fmac_f32 v10, v17, v28
v_and_b32 v28, s14, v183
v_fmac_f32 v11, v17, v28
v_lshlrev_b32 v28, 16, v184
v_fmac_f32 v4, v18, v28
v_and_b32 v28, s14, v184
v_fmac_f32 v5, v18, v28
v_lshlrev_b32 v28, 16, v185
v_fmac_f32 v6, v18, v28
v_and_b32 v28, s14, v185
v_fmac_f32 v7, v18, v28
v_lshlrev_b32 v28, 16, v186
v_fmac_f32 v8, v18, v28
v_and_b32 v28, s14, v186
v_fmac_f32 v9, v18, v28
v_lshlrev_b32 v28, 16, v187
v_fmac_f32 v10, v18, v28
v_and_b32 v28, s14, v187
v_fmac_f32 v11, v18, v28
v_lshlrev_b32 v28, 16, v188
v_fmac_f32 v4, v19, v28
v_and_b32 v28, s14, v188
v_fmac_f32 v5, v19, v28
v_lshlrev_b32 v28, 16, v189
v_fmac_f32 v6, v19, v28
v_and_b32 v28, s14, v189
v_fmac_f32 v7, v19, v28
v_lshlrev_b32 v28, 16, v190
v_fmac_f32 v8, v19, v28
v_and_b32 v28, s14, v190
v_fmac_f32 v9, v19, v28
v_lshlrev_b32 v28, 16, v191
v_fmac_f32 v10, v19, v28
v_and_b32 v28, s14, v191
v_fmac_f32 v11, v19, v28
s_waitcnt lgkmcnt(0)
ds_read_b128 v[12:15], v29 offset:8576
ds_read_b128 v[16:19], v29 offset:8592
s_barrier
s_waitcnt vmcnt(16)
v_lshlrev_b32 v28, 16, v192
v_fmac_f32 v4, v20, v28
v_and_b32 v28, s14, v192
v_fmac_f32 v5, v20, v28
v_lshlrev_b32 v28, 16, v193
v_fmac_f32 v6, v20, v28
v_and_b32 v28, s14, v193
v_fmac_f32 v7, v20, v28
v_lshlrev_b32 v28, 16, v194
v_fmac_f32 v8, v20, v28
v_and_b32 v28, s14, v194
v_fmac_f32 v9, v20, v28
v_lshlrev_b32 v28, 16, v195
v_fmac_f32 v10, v20, v28
v_and_b32 v28, s14, v195
v_fmac_f32 v11, v20, v28
v_lshlrev_b32 v28, 16, v196
v_fmac_f32 v4, v21, v28
v_and_b32 v28, s14, v196
v_fmac_f32 v5, v21, v28
v_lshlrev_b32 v28, 16, v197
v_fmac_f32 v6, v21, v28
v_and_b32 v28, s14, v197
v_fmac_f32 v7, v21, v28
v_lshlrev_b32 v28, 16, v198
v_fmac_f32 v8, v21, v28
v_and_b32 v28, s14, v198
v_fmac_f32 v9, v21, v28
v_lshlrev_b32 v28, 16, v199
v_fmac_f32 v10, v21, v28
v_and_b32 v28, s14, v199
v_fmac_f32 v11, v21, v28
v_lshlrev_b32 v28, 16, v200
v_fmac_f32 v4, v22, v28
v_and_b32 v28, s14, v200
v_fmac_f32 v5, v22, v28
v_lshlrev_b32 v28, 16, v201
v_fmac_f32 v6, v22, v28
v_and_b32 v28, s14, v201
v_fmac_f32 v7, v22, v28
v_lshlrev_b32 v28, 16, v202
v_fmac_f32 v8, v22, v28
v_and_b32 v28, s14, v202
v_fmac_f32 v9, v22, v28
v_lshlrev_b32 v28, 16, v203
v_fmac_f32 v10, v22, v28
v_and_b32 v28, s14, v203
v_fmac_f32 v11, v22, v28
v_lshlrev_b32 v28, 16, v204
v_fmac_f32 v4, v23, v28
v_and_b32 v28, s14, v204
v_fmac_f32 v5, v23, v28
v_lshlrev_b32 v28, 16, v205
v_fmac_f32 v6, v23, v28
v_and_b32 v28, s14, v205
v_fmac_f32 v7, v23, v28
v_lshlrev_b32 v28, 16, v206
v_fmac_f32 v8, v23, v28
v_and_b32 v28, s14, v206
v_fmac_f32 v9, v23, v28
v_lshlrev_b32 v28, 16, v207
v_fmac_f32 v10, v23, v28
v_and_b32 v28, s14, v207
v_fmac_f32 v11, v23, v28
v_lshlrev_b32 v28, 16, v208
v_fmac_f32 v4, v24, v28
v_and_b32 v28, s14, v208
v_fmac_f32 v5, v24, v28
v_lshlrev_b32 v28, 16, v209
v_fmac_f32 v6, v24, v28
v_and_b32 v28, s14, v209
v_fmac_f32 v7, v24, v28
v_lshlrev_b32 v28, 16, v210
v_fmac_f32 v8, v24, v28
v_and_b32 v28, s14, v210
v_fmac_f32 v9, v24, v28
v_lshlrev_b32 v28, 16, v211
v_fmac_f32 v10, v24, v28
v_and_b32 v28, s14, v211
v_fmac_f32 v11, v24, v28
v_lshlrev_b32 v28, 16, v212
v_fmac_f32 v4, v25, v28
v_and_b32 v28, s14, v212
v_fmac_f32 v5, v25, v28
v_lshlrev_b32 v28, 16, v213
v_fmac_f32 v6, v25, v28
v_and_b32 v28, s14, v213
v_fmac_f32 v7, v25, v28
v_lshlrev_b32 v28, 16, v214
v_fmac_f32 v8, v25, v28
v_and_b32 v28, s14, v214
v_fmac_f32 v9, v25, v28
v_lshlrev_b32 v28, 16, v215
v_fmac_f32 v10, v25, v28
v_and_b32 v28, s14, v215
v_fmac_f32 v11, v25, v28
v_lshlrev_b32 v28, 16, v216
v_fmac_f32 v4, v26, v28
v_and_b32 v28, s14, v216
v_fmac_f32 v5, v26, v28
v_lshlrev_b32 v28, 16, v217
v_fmac_f32 v6, v26, v28
v_and_b32 v28, s14, v217
v_fmac_f32 v7, v26, v28
v_lshlrev_b32 v28, 16, v218
v_fmac_f32 v8, v26, v28
v_and_b32 v28, s14, v218
v_fmac_f32 v9, v26, v28
v_lshlrev_b32 v28, 16, v219
v_fmac_f32 v10, v26, v28
v_and_b32 v28, s14, v219
v_fmac_f32 v11, v26, v28
v_lshlrev_b32 v28, 16, v220
v_fmac_f32 v4, v27, v28
v_and_b32 v28, s14, v220
v_fmac_f32 v5, v27, v28
v_lshlrev_b32 v28, 16, v221
v_fmac_f32 v6, v27, v28
v_and_b32 v28, s14, v221
v_fmac_f32 v7, v27, v28
v_lshlrev_b32 v28, 16, v222
v_fmac_f32 v8, v27, v28
v_and_b32 v28, s14, v222
v_fmac_f32 v9, v27, v28
v_lshlrev_b32 v28, 16, v223
v_fmac_f32 v10, v27, v28
v_and_b32 v28, s14, v223
v_fmac_f32 v11, v27, v28
s_waitcnt lgkmcnt(0)
ds_read_b128 v[20:23], v29 offset:8640
ds_read_b128 v[24:27], v29 offset:8656
s_barrier
s_waitcnt vmcnt(8)
v_lshlrev_b32 v28, 16, v224
v_fmac_f32 v4, v12, v28
v_and_b32 v28, s14, v224
v_fmac_f32 v5, v12, v28
v_lshlrev_b32 v28, 16, v225
v_fmac_f32 v6, v12, v28
v_and_b32 v28, s14, v225
v_fmac_f32 v7, v12, v28
v_lshlrev_b32 v28, 16, v226
v_fmac_f32 v8, v12, v28
v_and_b32 v28, s14, v226
v_fmac_f32 v9, v12, v28
v_lshlrev_b32 v28, 16, v227
v_fmac_f32 v10, v12, v28
v_and_b32 v28, s14, v227
v_fmac_f32 v11, v12, v28
v_lshlrev_b32 v28, 16, v228
v_fmac_f32 v4, v13, v28
v_and_b32 v28, s14, v228
v_fmac_f32 v5, v13, v28
v_lshlrev_b32 v28, 16, v229
v_fmac_f32 v6, v13, v28
v_and_b32 v28, s14, v229
v_fmac_f32 v7, v13, v28
v_lshlrev_b32 v28, 16, v230
v_fmac_f32 v8, v13, v28
v_and_b32 v28, s14, v230
v_fmac_f32 v9, v13, v28
v_lshlrev_b32 v28, 16, v231
v_fmac_f32 v10, v13, v28
v_and_b32 v28, s14, v231
v_fmac_f32 v11, v13, v28
v_lshlrev_b32 v28, 16, v232
v_fmac_f32 v4, v14, v28
v_and_b32 v28, s14, v232
v_fmac_f32 v5, v14, v28
v_lshlrev_b32 v28, 16, v233
v_fmac_f32 v6, v14, v28
v_and_b32 v28, s14, v233
v_fmac_f32 v7, v14, v28
v_lshlrev_b32 v28, 16, v234
v_fmac_f32 v8, v14, v28
v_and_b32 v28, s14, v234
v_fmac_f32 v9, v14, v28
v_lshlrev_b32 v28, 16, v235
v_fmac_f32 v10, v14, v28
v_and_b32 v28, s14, v235
v_fmac_f32 v11, v14, v28
v_lshlrev_b32 v28, 16, v236
v_fmac_f32 v4, v15, v28
v_and_b32 v28, s14, v236
v_fmac_f32 v5, v15, v28
v_lshlrev_b32 v28, 16, v237
v_fmac_f32 v6, v15, v28
v_and_b32 v28, s14, v237
v_fmac_f32 v7, v15, v28
v_lshlrev_b32 v28, 16, v238
v_fmac_f32 v8, v15, v28
v_and_b32 v28, s14, v238
v_fmac_f32 v9, v15, v28
v_lshlrev_b32 v28, 16, v239
v_fmac_f32 v10, v15, v28
v_and_b32 v28, s14, v239
v_fmac_f32 v11, v15, v28
v_lshlrev_b32 v28, 16, v240
v_fmac_f32 v4, v16, v28
v_and_b32 v28, s14, v240
v_fmac_f32 v5, v16, v28
v_lshlrev_b32 v28, 16, v241
v_fmac_f32 v6, v16, v28
v_and_b32 v28, s14, v241
v_fmac_f32 v7, v16, v28
v_lshlrev_b32 v28, 16, v242
v_fmac_f32 v8, v16, v28
v_and_b32 v28, s14, v242
v_fmac_f32 v9, v16, v28
v_lshlrev_b32 v28, 16, v243
v_fmac_f32 v10, v16, v28
v_and_b32 v28, s14, v243
v_fmac_f32 v11, v16, v28
v_lshlrev_b32 v28, 16, v244
v_fmac_f32 v4, v17, v28
v_and_b32 v28, s14, v244
v_fmac_f32 v5, v17, v28
v_lshlrev_b32 v28, 16, v245
v_fmac_f32 v6, v17, v28
v_and_b32 v28, s14, v245
v_fmac_f32 v7, v17, v28
v_lshlrev_b32 v28, 16, v246
v_fmac_f32 v8, v17, v28
v_and_b32 v28, s14, v246
v_fmac_f32 v9, v17, v28
v_lshlrev_b32 v28, 16, v247
v_fmac_f32 v10, v17, v28
v_and_b32 v28, s14, v247
v_fmac_f32 v11, v17, v28
v_lshlrev_b32 v28, 16, v248
v_fmac_f32 v4, v18, v28
v_and_b32 v28, s14, v248
v_fmac_f32 v5, v18, v28
v_lshlrev_b32 v28, 16, v249
v_fmac_f32 v6, v18, v28
v_and_b32 v28, s14, v249
v_fmac_f32 v7, v18, v28
v_lshlrev_b32 v28, 16, v250
v_fmac_f32 v8, v18, v28
v_and_b32 v28, s14, v250
v_fmac_f32 v9, v18, v28
v_lshlrev_b32 v28, 16, v251
v_fmac_f32 v10, v18, v28
v_and_b32 v28, s14, v251
v_fmac_f32 v11, v18, v28
v_lshlrev_b32 v28, 16, v252
v_fmac_f32 v4, v19, v28
v_and_b32 v28, s14, v252
v_fmac_f32 v5, v19, v28
v_lshlrev_b32 v28, 16, v253
v_fmac_f32 v6, v19, v28
v_and_b32 v28, s14, v253
v_fmac_f32 v7, v19, v28
v_lshlrev_b32 v28, 16, v254
v_fmac_f32 v8, v19, v28
v_and_b32 v28, s14, v254
v_fmac_f32 v9, v19, v28
v_lshlrev_b32 v28, 16, v255
v_fmac_f32 v10, v19, v28
v_and_b32 v28, s14, v255
v_fmac_f32 v11, v19, v28
s_waitcnt lgkmcnt(0)
s_barrier
s_waitcnt vmcnt(0)
v_lshlrev_b32 v28, 16, v64
v_fmac_f32 v4, v20, v28
v_and_b32 v28, s14, v64
v_fmac_f32 v5, v20, v28
v_lshlrev_b32 v28, 16, v65
v_fmac_f32 v6, v20, v28
v_and_b32 v28, s14, v65
v_fmac_f32 v7, v20, v28
v_lshlrev_b32 v28, 16, v66
v_fmac_f32 v8, v20, v28
v_and_b32 v28, s14, v66
v_fmac_f32 v9, v20, v28
v_lshlrev_b32 v28, 16, v67
v_fmac_f32 v10, v20, v28
v_and_b32 v28, s14, v67
v_fmac_f32 v11, v20, v28
v_lshlrev_b32 v28, 16, v68
v_fmac_f32 v4, v21, v28
v_and_b32 v28, s14, v68
v_fmac_f32 v5, v21, v28
v_lshlrev_b32 v28, 16, v69
v_fmac_f32 v6, v21, v28
v_and_b32 v28, s14, v69
v_fmac_f32 v7, v21, v28
v_lshlrev_b32 v28, 16, v70
v_fmac_f32 v8, v21, v28
v_and_b32 v28, s14, v70
v_fmac_f32 v9, v21, v28
v_lshlrev_b32 v28, 16, v71
v_fmac_f32 v10, v21, v28
v_and_b32 v28, s14, v71
v_fmac_f32 v11, v21, v28
v_lshlrev_b32 v28, 16, v72
v_fmac_f32 v4, v22, v28
v_and_b32 v28, s14, v72
v_fmac_f32 v5, v22, v28
v_lshlrev_b32 v28, 16, v73
v_fmac_f32 v6, v22, v28
v_and_b32 v28, s14, v73
v_fmac_f32 v7, v22, v28
v_lshlrev_b32 v28, 16, v74
v_fmac_f32 v8, v22, v28
v_and_b32 v28, s14, v74
v_fmac_f32 v9, v22, v28
v_lshlrev_b32 v28, 16, v75
v_fmac_f32 v10, v22, v28
v_and_b32 v28, s14, v75
v_fmac_f32 v11, v22, v28
v_lshlrev_b32 v28, 16, v76
v_fmac_f32 v4, v23, v28
v_and_b32 v28, s14, v76
v_fmac_f32 v5, v23, v28
v_lshlrev_b32 v28, 16, v77
v_fmac_f32 v6, v23, v28
v_and_b32 v28, s14, v77
v_fmac_f32 v7, v23, v28
v_lshlrev_b32 v28, 16, v78
v_fmac_f32 v8, v23, v28
v_and_b32 v28, s14, v78
v_fmac_f32 v9, v23, v28
v_lshlrev_b32 v28, 16, v79
v_fmac_f32 v10, v23, v28
v_and_b32 v28, s14, v79
v_fmac_f32 v11, v23, v28
v_lshlrev_b32 v28, 16, v80
v_fmac_f32 v4, v24, v28
v_and_b32 v28, s14, v80
v_fmac_f32 v5, v24, v28
v_lshlrev_b32 v28, 16, v81
v_fmac_f32 v6, v24, v28
v_and_b32 v28, s14, v81
v_fmac_f32 v7, v24, v28
v_lshlrev_b32 v28, 16, v82
v_fmac_f32 v8, v24, v28
v_and_b32 v28, s14, v82
v_fmac_f32 v9, v24, v28
v_lshlrev_b32 v28, 16, v83
v_fmac_f32 v10, v24, v28
v_and_b32 v28, s14, v83
v_fmac_f32 v11, v24, v28
v_lshlrev_b32 v28, 16, v84
v_fmac_f32 v4, v25, v28
v_and_b32 v28, s14, v84
v_fmac_f32 v5, v25, v28
v_lshlrev_b32 v28, 16, v85
v_fmac_f32 v6, v25, v28
v_and_b32 v28, s14, v85
v_fmac_f32 v7, v25, v28
v_lshlrev_b32 v28, 16, v86
v_fmac_f32 v8, v25, v28
v_and_b32 v28, s14, v86
v_fmac_f32 v9, v25, v28
v_lshlrev_b32 v28, 16, v87
v_fmac_f32 v10, v25, v28
v_and_b32 v28, s14, v87
v_fmac_f32 v11, v25, v28
v_lshlrev_b32 v28, 16, v88
v_fmac_f32 v4, v26, v28
v_and_b32 v28, s14, v88
v_fmac_f32 v5, v26, v28
v_lshlrev_b32 v28, 16, v89
v_fmac_f32 v6, v26, v28
v_and_b32 v28, s14, v89
v_fmac_f32 v7, v26, v28
v_lshlrev_b32 v28, 16, v90
v_fmac_f32 v8, v26, v28
v_and_b32 v28, s14, v90
v_fmac_f32 v9, v26, v28
v_lshlrev_b32 v28, 16, v91
v_fmac_f32 v10, v26, v28
v_and_b32 v28, s14, v91
v_fmac_f32 v11, v26, v28
v_lshlrev_b32 v28, 16, v92
v_fmac_f32 v4, v27, v28
v_and_b32 v28, s14, v92
v_fmac_f32 v5, v27, v28
v_lshlrev_b32 v28, 16, v93
v_fmac_f32 v6, v27, v28
v_and_b32 v28, s14, v93
v_fmac_f32 v7, v27, v28
v_lshlrev_b32 v28, 16, v94
v_fmac_f32 v8, v27, v28
v_and_b32 v28, s14, v94
v_fmac_f32 v9, v27, v28
v_lshlrev_b32 v28, 16, v95
v_fmac_f32 v10, v27, v28
v_and_b32 v28, s14, v95
v_fmac_f32 v11, v27, v28
s_lshl_b32 s9, s6, 11
v_lshlrev_b32 v12, 5, v1
v_add_u32 v12, s9, v12
ds_write_b128 v12, v[4:7] offset:16384
ds_write_b128 v12, v[8:11] offset:16400
s_lshl_b32 s9, s6, 3
v_mov_b32 v12, s9
s_mov_b64 exec, 1
ds_write_b64 v12, v[30:31] offset:5952
s_mov_b64 exec, -1
s_waitcnt lgkmcnt(0)
s_barrier
s_cmp_lt_u32 s6, 4
s_cbranch_scc0 L_pub_a
v_mov_b32 v12, 0
ds_read_b128 v[64:67], v12 offset:5952
ds_read_b128 v[68:71], v12 offset:5968
ds_read_b128 v[72:75], v12 offset:5984
ds_read_b128 v[76:79], v12 offset:6000
v_lshlrev_b32 v12, 2, v0
ds_read_b32 v80, v12 offset:16384
ds_read_b32 v81, v12 offset:17408
ds_read_b32 v82, v12 offset:18432
ds_read_b32 v83, v12 offset:19456
ds_read_b32 v84, v12 offset:20480
ds_read_b32 v85, v12 offset:21504
ds_read_b32 v86, v12 offset:22528
ds_read_b32 v87, v12 offset:23552
ds_read_b32 v88, v12 offset:24576
ds_read_b32 v89, v12 offset:25600
ds_read_b32 v90, v12 offset:26624
ds_read_b32 v91, v12 offset:27648
ds_read_b32 v92, v12 offset:28672
ds_read_b32 v93, v12 offset:29696
ds_read_b32 v94, v12 offset:30720
ds_read_b32 v95, v12 offset:31744
s_waitcnt lgkmcnt(0)
v_max3_f32 v30, v64, v66, v68
v_max3_f32 v30, v30, v70, v72
v_max3_f32 v30, v30, v74, v76
v_max_f32 v30, v30, v78
v_mov_b32 v31, 0
v_mov_b32 v13, 0
v_sub_f32 v14, v64, v30
v_mul_f32 v14, s13, v14
v_exp_f32 v14, v14
v_add_f32 v15, v80, v81
v_fmac_f32 v31, v14, v65
v_fmac_f32 v13, v14, v15
v_sub_f32 v14, v66, v30
v_mul_f32 v14, s13, v14
v_exp_f32 v14, v14
v_add_f32 v15, v82, v83
v_fmac_f32 v31, v14, v67
v_fmac_f32 v13, v14, v15
v_sub_f32 v14, v68, v30
v_mul_f32 v14, s13, v14
v_exp_f32 v14, v14
v_add_f32 v15, v84, v85
v_fmac_f32 v31, v14, v69
v_fmac_f32 v13, v14, v15
v_sub_f32 v14, v70, v30
v_mul_f32 v14, s13, v14
v_exp_f32 v14, v14
v_add_f32 v15, v86, v87
v_fmac_f32 v31, v14, v71
v_fmac_f32 v13, v14, v15
v_sub_f32 v14, v72, v30
v_mul_f32 v14, s13, v14
v_exp_f32 v14, v14
v_add_f32 v15, v88, v89
v_fmac_f32 v31, v14, v73
v_fmac_f32 v13, v14, v15
v_sub_f32 v14, v74, v30
v_mul_f32 v14, s13, v14
v_exp_f32 v14, v14
v_add_f32 v15, v90, v91
v_fmac_f32 v31, v14, v75
v_fmac_f32 v13, v14, v15
v_sub_f32 v14, v76, v30
v_mul_f32 v14, s13, v14
v_exp_f32 v14, v14
v_add_f32 v15, v92, v93
v_fmac_f32 v31, v14, v77
v_fmac_f32 v13, v14, v15
v_sub_f32 v14, v78, v30
v_mul_f32 v14, s13, v14
v_exp_f32 v14, v14
v_add_f32 v15, v94, v95
v_fmac_f32 v31, v14, v79
v_fmac_f32 v13, v14, v15
s_lshl_b32 s15, s7, 3
s_add_u32 s15, s15, s5
s_lshl_b32 s9, s15, 11
s_add_u32 s9, s9, 0x10000
v_mov_b32 v14, v13
v_mov_b32 v15, s16
v_lshlrev_b32 v12, 3, v0
buffer_store_dwordx2 v[14:15], v12, s[76:79], s9 offen sc1
s_cmp_eq_u32 s6, 0
s_cbranch_scc0 L_pub_a
v_mov_b32 v16, v30
v_mov_b32 v17, s16
v_mov_b32 v18, v31
v_mov_b32 v19, s16
s_lshl_b32 s9, s15, 4
s_add_u32 s9, s9, 0x90000
s_mov_b64 exec, 1
buffer_store_dwordx4 v[16:19], v12, s[76:79], s9 offen sc1
v_mov_b32 v26, 1
v_mov_b32 v27, 4
v_mov_b32 v25, 0
buffer_atomic_add v26, v27, s[72:75], 0 offen sc0
s_waitcnt vmcnt(0)
ds_write_b32 v25, v26 offset:5888
s_mov_b64 exec, -1
L_pub_a:
L_role_a:
s_waitcnt lgkmcnt(0)
s_barrier
v_mov_b32 v5, 0
ds_read_b32 v4, v5 offset:5888
s_waitcnt lgkmcnt(0)
v_readfirstlane_b32 s5, v4
v_mov_b32 v5, 0x7f000000
v_cmp_gt_u32 vcc, 56, v1
s_nop 1
v_cndmask_b32 v31, v5, v3, vcc
s_cmp_ge_u32 s5, 120
s_cbranch_scc1 L_end
s_cmp_ge_u32 s5, 56
s_cbranch_scc1 L_cmb
s_branch L_ffn
L_ffn:
buffer_load_dwordx4 v[8:11], v31, s[40:43], 0 offen
buffer_load_dwordx4 v[12:15], v31, s[40:43], 0 offen offset:896
v_lshrrev_b32 v6, 2, v1
s_movk_i32 s9, 3584
v_mul_lo_u32 v6, v6, s9
v_and_b32 v7, 3, v1
v_lshl_add_u32 v6, v7, 4, v6
s_and_b32 s9, s6, 3
s_mul_i32 s9, s9, 401408
s_lshl_b32 s10, s5, 6
s_add_u32 s9, s9, s10
buffer_load_dwordx4 v[96:99], v6, s[60:63], s9 offen nt
s_add_u32 s9, s9, 57344
buffer_load_dwordx4 v[100:103], v6, s[60:63], s9 offen nt
s_add_u32 s9, s9, 57344
buffer_load_dwordx4 v[104:107], v6, s[60:63], s9 offen nt
s_add_u32 s9, s9, 57344
buffer_load_dwordx4 v[108:111], v6, s[60:63], s9 offen nt
s_add_u32 s9, s9, 57344
buffer_load_dwordx4 v[112:115], v6, s[60:63], s9 offen nt
s_add_u32 s9, s9, 57344
buffer_load_dwordx4 v[116:119], v6, s[60:63], s9 offen nt
s_add_u32 s9, s9, 57344
buffer_load_dwordx4 v[120:123], v6, s[60:63], s9 offen nt
s_lshl_b32 s9, s5, 3
s_add_u32 s9, s9, s6
s_mul_i32 s9, s9, 3584
buffer_load_dwordx4 v[192:195], v31, s[64:67], s9 offen offset:0 nt
buffer_load_dwordx4 v[196:199], v31, s[64:67], s9 offen offset:896 nt
buffer_load_dwordx4 v[200:203], v31, s[64:67], s9 offen offset:1792 nt
buffer_load_dwordx4 v[204:207], v31, s[64:67], s9 offen offset:2688 nt
s_waitcnt vmcnt(11)
v_lshlrev_b32 v16, 16, v8
v_and_b32 v17, s14, v8
v_lshlrev_b32 v18, 16, v9
v_and_b32 v19, s14, v9
v_lshlrev_b32 v20, 16, v10
v_and_b32 v21, s14, v10
v_lshlrev_b32 v22, 16, v11
v_and_b32 v23, s14, v11
v_add_f32 v24, v16, v17
v_add_f32 v24, v24, v18
v_add_f32 v24, v24, v19
v_add_f32 v24, v24, v20
v_add_f32 v24, v24, v21
v_add_f32 v24, v24, v22
v_add_f32 v24, v24, v23
s_nop 1
v_add_f32_dpp v25, v24, v24 row_ror:8 row_mask:0xf bank_mask:0xf
v_mov_b32 v24, v25
s_nop 1
v_add_f32_dpp v25, v24, v24 row_ror:4 row_mask:0xf bank_mask:0xf
v_mov_b32 v24, v25
s_nop 1
v_add_f32_dpp v25, v24, v24 row_ror:2 row_mask:0xf bank_mask:0xf
v_mov_b32 v24, v25
s_nop 1
v_add_f32_dpp v25, v24, v24 row_ror:1 row_mask:0xf bank_mask:0xf
v_mov_b32 v24, v25
s_nop 0
v_readlane_b32 s80, v24, 0
v_readlane_b32 s81, v24, 16
v_readlane_b32 s82, v24, 32
v_readlane_b32 s83, v24, 48
s_nop 1
v_mov_b32 v24, s80
v_add_f32 v24, s81, v24
v_add_f32 v24, s82, v24
v_add_f32 v24, s83, v24
v_mul_f32 v25, 0x3b124925, v24
v_mov_b32 v26, 0x43e00000
v_fma_f32 v26, -v25, v26, v24
v_mul_f32 v26, 0x3b124925, v26
v_add_f32 v24, v25, v26
v_mov_b32 v27, 0
v_sub_f32 v25, v16, v24
v_fmac_f32 v27, v25, v25
v_sub_f32 v25, v17, v24
v_fmac_f32 v27, v25, v25
v_sub_f32 v25, v18, v24
v_fmac_f32 v27, v25, v25
v_sub_f32 v25, v19, v24
v_fmac_f32 v27, v25, v25
v_sub_f32 v25, v20, v24
v_fmac_f32 v27, v25, v25
v_sub_f32 v25, v21, v24
v_fmac_f32 v27, v25, v25
v_sub_f32 v25, v22, v24
v_fmac_f32 v27, v25, v25
v_sub_f32 v25, v23, v24
v_fmac_f32 v27, v25, v25
v_cmp_gt_u32 vcc, 56, v1
s_nop 1
v_cndmask_b32 v27, 0, v27, vcc
s_nop 1
v_add_f32_dpp v25, v27, v27 row_ror:8 row_mask:0xf bank_mask:0xf
v_mov_b32 v27, v25
s_nop 1
v_add_f32_dpp v25, v27, v27 row_ror:4 row_mask:0xf bank_mask:0xf
v_mov_b32 v27, v25
s_nop 1
v_add_f32_dpp v25, v27, v27 row_ror:2 row_mask:0xf bank_mask:0xf
v_mov_b32 v27, v25
s_nop 1
v_add_f32_dpp v25, v27, v27 row_ror:1 row_mask:0xf bank_mask:0xf
v_mov_b32 v27, v25
s_nop 0
v_readlane_b32 s80, v27, 0
v_readlane_b32 s81, v27, 16
v_readlane_b32 s82, v27, 32
v_readlane_b32 s83, v27, 48
s_nop 1
v_mov_b32 v27, s80
v_add_f32 v27, s81, v27
v_add_f32 v27, s82, v27
v_add_f32 v27, s83, v27
v_mul_f32 v25, 0x3b124925, v27
v_mov_b32 v26, 0x43e00000
v_fma_f32 v26, -v25, v26, v27
v_mul_f32 v26, 0x3b124925, v26
v_add_f32 v27, v25, v26
v_cvt_pk_bf16_f32 v27, 0, v27
v_cvt_pk_bf16_f32 v24, 0, v24
v_add_f32 v27, 0x3727c5ac, v27
v_cvt_pk_bf16_f32 v27, 0, v27
v_sqrt_f32 v27, v27
s_nop 0
v_cvt_pk_bf16_f32 v27, 0, v27
v_rcp_f32 v28, v27
s_nop 0
v_sub_f32 v16, v16, v24
v_cvt_pk_bf16_f32 v16, 0, v16
v_mul_f32 v25, v16, v28
v_fma_f32 v26, -v25, v27, v16
v_fma_f32 v16, v26, v28, v25
v_sub_f32 v17, v17, v24
v_cvt_pk_bf16_f32 v17, 0, v17
v_mul_f32 v25, v17, v28
v_fma_f32 v26, -v25, v27, v17
v_fma_f32 v17, v26, v28, v25
v_sub_f32 v18, v18, v24
v_cvt_pk_bf16_f32 v18, 0, v18
v_mul_f32 v25, v18, v28
v_fma_f32 v26, -v25, v27, v18
v_fma_f32 v18, v26, v28, v25
v_sub_f32 v19, v19, v24
v_cvt_pk_bf16_f32 v19, 0, v19
v_mul_f32 v25, v19, v28
v_fma_f32 v26, -v25, v27, v19
v_fma_f32 v19, v26, v28, v25
v_sub_f32 v20, v20, v24
v_cvt_pk_bf16_f32 v20, 0, v20
v_mul_f32 v25, v20, v28
v_fma_f32 v26, -v25, v27, v20
v_fma_f32 v20, v26, v28, v25
v_sub_f32 v21, v21, v24
v_cvt_pk_bf16_f32 v21, 0, v21
v_mul_f32 v25, v21, v28
v_fma_f32 v26, -v25, v27, v21
v_fma_f32 v21, v26, v28, v25
v_sub_f32 v22, v22, v24
v_cvt_pk_bf16_f32 v22, 0, v22
v_mul_f32 v25, v22, v28
v_fma_f32 v26, -v25, v27, v22
v_fma_f32 v22, v26, v28, v25
v_sub_f32 v23, v23, v24
v_cvt_pk_bf16_f32 v23, 0, v23
v_mul_f32 v25, v23, v28
v_fma_f32 v26, -v25, v27, v23
v_fma_f32 v23, v26, v28, v25
v_cvt_pk_bf16_f32 v8, v16, v17
v_cvt_pk_bf16_f32 v9, v18, v19
v_cvt_pk_bf16_f32 v10, v20, v21
v_cvt_pk_bf16_f32 v11, v22, v23
v_lshlrev_b32 v16, 16, v8
v_and_b32 v17, s14, v8
v_lshlrev_b32 v18, 16, v9
v_and_b32 v19, s14, v9
v_lshlrev_b32 v20, 16, v10
v_and_b32 v21, s14, v10
v_lshlrev_b32 v22, 16, v11
v_and_b32 v23, s14, v11
s_mov_b32 exec_hi, 0x00ffffff
v_lshlrev_b32 v25, 5, v1
ds_write_b128 v25, v[16:19] offset:0
ds_write_b128 v25, v[20:23] offset:16
s_mov_b32 exec_hi, -1
v_lshlrev_b32 v16, 16, v12
v_and_b32 v17, s14, v12
v_lshlrev_b32 v18, 16, v13
v_and_b32 v19, s14, v13
v_lshlrev_b32 v20, 16, v14
v_and_b32 v21, s14, v14
v_lshlrev_b32 v22, 16, v15
v_and_b32 v23, s14, v15
v_add_f32 v24, v16, v17
v_add_f32 v24, v24, v18
v_add_f32 v24, v24, v19
v_add_f32 v24, v24, v20
v_add_f32 v24, v24, v21
v_add_f32 v24, v24, v22
v_add_f32 v24, v24, v23
s_nop 1
v_add_f32_dpp v25, v24, v24 row_ror:8 row_mask:0xf bank_mask:0xf
v_mov_b32 v24, v25
s_nop 1
v_add_f32_dpp v25, v24, v24 row_ror:4 row_mask:0xf bank_mask:0xf
v_mov_b32 v24, v25
s_nop 1
v_add_f32_dpp v25, v24, v24 row_ror:2 row_mask:0xf bank_mask:0xf
v_mov_b32 v24, v25
s_nop 1
v_add_f32_dpp v25, v24, v24 row_ror:1 row_mask:0xf bank_mask:0xf
v_mov_b32 v24, v25
s_nop 0
v_readlane_b32 s80, v24, 0
v_readlane_b32 s81, v24, 16
v_readlane_b32 s82, v24, 32
v_readlane_b32 s83, v24, 48
s_nop 1
v_mov_b32 v24, s80
v_add_f32 v24, s81, v24
v_add_f32 v24, s82, v24
v_add_f32 v24, s83, v24
v_mul_f32 v25, 0x3b124925, v24
v_mov_b32 v26, 0x43e00000
v_fma_f32 v26, -v25, v26, v24
v_mul_f32 v26, 0x3b124925, v26
v_add_f32 v24, v25, v26
v_mov_b32 v27, 0
v_sub_f32 v25, v16, v24
v_fmac_f32 v27, v25, v25
v_sub_f32 v25, v17, v24
v_fmac_f32 v27, v25, v25
v_sub_f32 v25, v18, v24
v_fmac_f32 v27, v25, v25
v_sub_f32 v25, v19, v24
v_fmac_f32 v27, v25, v25
v_sub_f32 v25, v20, v24
v_fmac_f32 v27, v25, v25
v_sub_f32 v25, v21, v24
v_fmac_f32 v27, v25, v25
v_sub_f32 v25, v22, v24
v_fmac_f32 v27, v25, v25
v_sub_f32 v25, v23, v24
v_fmac_f32 v27, v25, v25
v_cmp_gt_u32 vcc, 56, v1
s_nop 1
v_cndmask_b32 v27, 0, v27, vcc
s_nop 1
v_add_f32_dpp v25, v27, v27 row_ror:8 row_mask:0xf bank_mask:0xf
v_mov_b32 v27, v25
s_nop 1
v_add_f32_dpp v25, v27, v27 row_ror:4 row_mask:0xf bank_mask:0xf
v_mov_b32 v27, v25
s_nop 1
v_add_f32_dpp v25, v27, v27 row_ror:2 row_mask:0xf bank_mask:0xf
v_mov_b32 v27, v25
s_nop 1
v_add_f32_dpp v25, v27, v27 row_ror:1 row_mask:0xf bank_mask:0xf
v_mov_b32 v27, v25
s_nop 0
v_readlane_b32 s80, v27, 0
v_readlane_b32 s81, v27, 16
v_readlane_b32 s82, v27, 32
v_readlane_b32 s83, v27, 48
s_nop 1
v_mov_b32 v27, s80
v_add_f32 v27, s81, v27
v_add_f32 v27, s82, v27
v_add_f32 v27, s83, v27
v_mul_f32 v25, 0x3b124925, v27
v_mov_b32 v26, 0x43e00000
v_fma_f32 v26, -v25, v26, v27
v_mul_f32 v26, 0x3b124925, v26
v_add_f32 v27, v25, v26
v_cvt_pk_bf16_f32 v27, 0, v27
v_cvt_pk_bf16_f32 v24, 0, v24
v_add_f32 v27, 0x3727c5ac, v27
v_cvt_pk_bf16_f32 v27, 0, v27
v_sqrt_f32 v27, v27
s_nop 0
v_cvt_pk_bf16_f32 v27, 0, v27
v_rcp_f32 v28, v27
s_nop 0
v_sub_f32 v16, v16, v24
v_cvt_pk_bf16_f32 v16, 0, v16
v_mul_f32 v25, v16, v28
v_fma_f32 v26, -v25, v27, v16
v_fma_f32 v16, v26, v28, v25
v_sub_f32 v17, v17, v24
v_cvt_pk_bf16_f32 v17, 0, v17
v_mul_f32 v25, v17, v28
v_fma_f32 v26, -v25, v27, v17
v_fma_f32 v17, v26, v28, v25
v_sub_f32 v18, v18, v24
v_cvt_pk_bf16_f32 v18, 0, v18
v_mul_f32 v25, v18, v28
v_fma_f32 v26, -v25, v27, v18
v_fma_f32 v18, v26, v28, v25
v_sub_f32 v19, v19, v24
v_cvt_pk_bf16_f32 v19, 0, v19
v_mul_f32 v25, v19, v28
v_fma_f32 v26, -v25, v27, v19
v_fma_f32 v19, v26, v28, v25
v_sub_f32 v20, v20, v24
v_cvt_pk_bf16_f32 v20, 0, v20
v_mul_f32 v25, v20, v28
v_fma_f32 v26, -v25, v27, v20
v_fma_f32 v20, v26, v28, v25
v_sub_f32 v21, v21, v24
v_cvt_pk_bf16_f32 v21, 0, v21
v_mul_f32 v25, v21, v28
v_fma_f32 v26, -v25, v27, v21
v_fma_f32 v21, v26, v28, v25
v_sub_f32 v22, v22, v24
v_cvt_pk_bf16_f32 v22, 0, v22
v_mul_f32 v25, v22, v28
v_fma_f32 v26, -v25, v27, v22
v_fma_f32 v22, v26, v28, v25
v_sub_f32 v23, v23, v24
v_cvt_pk_bf16_f32 v23, 0, v23
v_mul_f32 v25, v23, v28
v_fma_f32 v26, -v25, v27, v23
v_fma_f32 v23, v26, v28, v25
v_cvt_pk_bf16_f32 v12, v16, v17
v_cvt_pk_bf16_f32 v13, v18, v19
v_cvt_pk_bf16_f32 v14, v20, v21
v_cvt_pk_bf16_f32 v15, v22, v23
v_lshlrev_b32 v16, 16, v12
v_and_b32 v17, s14, v12
v_lshlrev_b32 v18, 16, v13
v_and_b32 v19, s14, v13
v_lshlrev_b32 v20, 16, v14
v_and_b32 v21, s14, v14
v_lshlrev_b32 v22, 16, v15
v_and_b32 v23, s14, v15
s_mov_b32 exec_hi, 0x00ffffff
v_lshlrev_b32 v25, 5, v1
ds_write_b128 v25, v[16:19] offset:1792
ds_write_b128 v25, v[20:23] offset:1808
s_mov_b32 exec_hi, -1
s_and_b32 s9, s6, 3
s_mul_i32 s9, s9, 448
v_lshrrev_b32 v26, 2, v1
v_lshlrev_b32 v26, 2, v26
v_add_u32 v26, s9, v26
v_mov_b32 v4, 0
v_mov_b32 v5, 0
v_mov_b32 v6, 0
v_mov_b32 v7, 0
v_mov_b32 v8, 0
v_mov_b32 v9, 0
v_mov_b32 v10, 0
v_mov_b32 v11, 0
v_mov_b32 v12, 0
v_mov_b32 v13, 0
v_mov_b32 v14, 0
v_mov_b32 v15, 0
v_mov_b32 v16, 0
v_mov_b32 v17, 0
v_mov_b32 v18, 0
v_mov_b32 v19, 0
s_waitcnt lgkmcnt(0)
ds_read_b32 v128, v26 offset:0
ds_read_b32 v129, v26 offset:1792
ds_read_b32 v130, v26 offset:64
ds_read_b32 v131, v26 offset:1856
ds_read_b32 v132, v26 offset:128
ds_read_b32 v133, v26 offset:1920
ds_read_b32 v134, v26 offset:192
ds_read_b32 v135, v26 offset:1984
ds_read_b32 v136, v26 offset:256
ds_read_b32 v137, v26 offset:2048
ds_read_b32 v138, v26 offset:320
ds_read_b32 v139, v26 offset:2112
ds_read_b32 v140, v26 offset:384
ds_read_b32 v141, v26 offset:2176
s_waitcnt lgkmcnt(0)
s_waitcnt vmcnt(4)
v_lshlrev_b32 v22, 16, v96
v_and_b32 v23, s14, v96
v_fmac_f32 v4, v128, v22
v_fmac_f32 v5, v128, v23
v_fmac_f32 v12, v129, v22
v_fmac_f32 v13, v129, v23
v_lshlrev_b32 v22, 16, v97
v_and_b32 v23, s14, v97
v_fmac_f32 v6, v128, v22
v_fmac_f32 v7, v128, v23
v_fmac_f32 v14, v129, v22
v_fmac_f32 v15, v129, v23
v_lshlrev_b32 v22, 16, v98
v_and_b32 v23, s14, v98
v_fmac_f32 v8, v128, v22
v_fmac_f32 v9, v128, v23
v_fmac_f32 v16, v129, v22
v_fmac_f32 v17, v129, v23
v_lshlrev_b32 v22, 16, v99
v_and_b32 v23, s14, v99
v_fmac_f32 v10, v128, v22
v_fmac_f32 v11, v128, v23
v_fmac_f32 v18, v129, v22
v_fmac_f32 v19, v129, v23
v_lshlrev_b32 v22, 16, v100
v_and_b32 v23, s14, v100
v_fmac_f32 v4, v130, v22
v_fmac_f32 v5, v130, v23
v_fmac_f32 v12, v131, v22
v_fmac_f32 v13, v131, v23
v_lshlrev_b32 v22, 16, v101
v_and_b32 v23, s14, v101
v_fmac_f32 v6, v130, v22
v_fmac_f32 v7, v130, v23
v_fmac_f32 v14, v131, v22
v_fmac_f32 v15, v131, v23
v_lshlrev_b32 v22, 16, v102
v_and_b32 v23, s14, v102
v_fmac_f32 v8, v130, v22
v_fmac_f32 v9, v130, v23
v_fmac_f32 v16, v131, v22
v_fmac_f32 v17, v131, v23
v_lshlrev_b32 v22, 16, v103
v_and_b32 v23, s14, v103
v_fmac_f32 v10, v130, v22
v_fmac_f32 v11, v130, v23
v_fmac_f32 v18, v131, v22
v_fmac_f32 v19, v131, v23
v_lshlrev_b32 v22, 16, v104
v_and_b32 v23, s14, v104
v_fmac_f32 v4, v132, v22
v_fmac_f32 v5, v132, v23
v_fmac_f32 v12, v133, v22
v_fmac_f32 v13, v133, v23
v_lshlrev_b32 v22, 16, v105
v_and_b32 v23, s14, v105
v_fmac_f32 v6, v132, v22
v_fmac_f32 v7, v132, v23
v_fmac_f32 v14, v133, v22
v_fmac_f32 v15, v133, v23
v_lshlrev_b32 v22, 16, v106
v_and_b32 v23, s14, v106
v_fmac_f32 v8, v132, v22
v_fmac_f32 v9, v132, v23
v_fmac_f32 v16, v133, v22
v_fmac_f32 v17, v133, v23
v_lshlrev_b32 v22, 16, v107
v_and_b32 v23, s14, v107
v_fmac_f32 v10, v132, v22
v_fmac_f32 v11, v132, v23
v_fmac_f32 v18, v133, v22
v_fmac_f32 v19, v133, v23
v_lshlrev_b32 v22, 16, v108
v_and_b32 v23, s14, v108
v_fmac_f32 v4, v134, v22
v_fmac_f32 v5, v134, v23
v_fmac_f32 v12, v135, v22
v_fmac_f32 v13, v135, v23
v_lshlrev_b32 v22, 16, v109
v_and_b32 v23, s14, v109
v_fmac_f32 v6, v134, v22
v_fmac_f32 v7, v134, v23
v_fmac_f32 v14, v135, v22
v_fmac_f32 v15, v135, v23
v_lshlrev_b32 v22, 16, v110
v_and_b32 v23, s14, v110
v_fmac_f32 v8, v134, v22
v_fmac_f32 v9, v134, v23
v_fmac_f32 v16, v135, v22
v_fmac_f32 v17, v135, v23
v_lshlrev_b32 v22, 16, v111
v_and_b32 v23, s14, v111
v_fmac_f32 v10, v134, v22
v_fmac_f32 v11, v134, v23
v_fmac_f32 v18, v135, v22
v_fmac_f32 v19, v135, v23
v_lshlrev_b32 v22, 16, v112
v_and_b32 v23, s14, v112
v_fmac_f32 v4, v136, v22
v_fmac_f32 v5, v136, v23
v_fmac_f32 v12, v137, v22
v_fmac_f32 v13, v137, v23
v_lshlrev_b32 v22, 16, v113
v_and_b32 v23, s14, v113
v_fmac_f32 v6, v136, v22
v_fmac_f32 v7, v136, v23
v_fmac_f32 v14, v137, v22
v_fmac_f32 v15, v137, v23
v_lshlrev_b32 v22, 16, v114
v_and_b32 v23, s14, v114
v_fmac_f32 v8, v136, v22
v_fmac_f32 v9, v136, v23
v_fmac_f32 v16, v137, v22
v_fmac_f32 v17, v137, v23
v_lshlrev_b32 v22, 16, v115
v_and_b32 v23, s14, v115
v_fmac_f32 v10, v136, v22
v_fmac_f32 v11, v136, v23
v_fmac_f32 v18, v137, v22
v_fmac_f32 v19, v137, v23
v_lshlrev_b32 v22, 16, v116
v_and_b32 v23, s14, v116
v_fmac_f32 v4, v138, v22
v_fmac_f32 v5, v138, v23
v_fmac_f32 v12, v139, v22
v_fmac_f32 v13, v139, v23
v_lshlrev_b32 v22, 16, v117
v_and_b32 v23, s14, v117
v_fmac_f32 v6, v138, v22
v_fmac_f32 v7, v138, v23
v_fmac_f32 v14, v139, v22
v_fmac_f32 v15, v139, v23
v_lshlrev_b32 v22, 16, v118
v_and_b32 v23, s14, v118
v_fmac_f32 v8, v138, v22
v_fmac_f32 v9, v138, v23
v_fmac_f32 v16, v139, v22
v_fmac_f32 v17, v139, v23
v_lshlrev_b32 v22, 16, v119
v_and_b32 v23, s14, v119
v_fmac_f32 v10, v138, v22
v_fmac_f32 v11, v138, v23
v_fmac_f32 v18, v139, v22
v_fmac_f32 v19, v139, v23
v_lshlrev_b32 v22, 16, v120
v_and_b32 v23, s14, v120
v_fmac_f32 v4, v140, v22
v_fmac_f32 v5, v140, v23
v_fmac_f32 v12, v141, v22
v_fmac_f32 v13, v141, v23
v_lshlrev_b32 v22, 16, v121
v_and_b32 v23, s14, v121
v_fmac_f32 v6, v140, v22
v_fmac_f32 v7, v140, v23
v_fmac_f32 v14, v141, v22
v_fmac_f32 v15, v141, v23
v_lshlrev_b32 v22, 16, v122
v_and_b32 v23, s14, v122
v_fmac_f32 v8, v140, v22
v_fmac_f32 v9, v140, v23
v_fmac_f32 v16, v141, v22
v_fmac_f32 v17, v141, v23
v_lshlrev_b32 v22, 16, v123
v_and_b32 v23, s14, v123
v_fmac_f32 v10, v140, v22
v_fmac_f32 v11, v140, v23
v_fmac_f32 v18, v141, v22
v_fmac_f32 v19, v141, v23
v_lshrrev_b32 v27, 2, v1
v_lshlrev_b32 v27, 8, v27
v_and_b32 v22, 3, v1
v_lshl_add_u32 v27, v22, 5, v27
s_lshl_b32 s9, s6, 12
v_add_u32 v27, s9, v27
ds_write_b128 v27, v[4:7] offset:16384
ds_write_b128 v27, v[8:11] offset:16400
ds_write_b128 v27, v[12:15] offset:16512
ds_write_b128 v27, v[16:19] offset:16528
s_waitcnt lgkmcnt(0)
s_barrier
s_cmp_lt_u32 s6, 2
s_cbranch_scc0 L_ffn_a
s_lshl_b32 s9, s6, 14
v_lshlrev_b32 v26, 2, v1
v_add_u32 v26, s9, v26
ds_read_b32 v128, v26 offset:16384
ds_read_b32 v129, v26 offset:16640
ds_read_b32 v130, v26 offset:16896
ds_read_b32 v131, v26 offset:17152
ds_read_b32 v132, v26 offset:17408
ds_read_b32 v133, v26 offset:17664
ds_read_b32 v134, v26 offset:17920
ds_read_b32 v135, v26 offset:18176
ds_read_b32 v136, v26 offset:18432
ds_read_b32 v137, v26 offset:18688
ds_read_b32 v138, v26 offset:18944
ds_read_b32 v139, v26 offset:19200
ds_read_b32 v140, v26 offset:19456
ds_read_b32 v141, v26 offset:19712
ds_read_b32 v142, v26 offset:19968
ds_read_b32 v143, v26 offset:20224
ds_read_b32 v144, v26 offset:20480
ds_read_b32 v145, v26 offset:20736
ds_read_b32 v146, v26 offset:20992
ds_read_b32 v147, v26 offset:21248
ds_read_b32 v148, v26 offset:21504
ds_read_b32 v149, v26 offset:21760
ds_read_b32 v150, v26 offset:22016
ds_read_b32 v151, v26 offset:22272
ds_read_b32 v152, v26 offset:22528
ds_read_b32 v153, v26 offset:22784
ds_read_b32 v154, v26 offset:23040
ds_read_b32 v155, v26 offset:23296
ds_read_b32 v156, v26 offset:23552
ds_read_b32 v157, v26 offset:23808
ds_read_b32 v158, v26 offset:24064
ds_read_b32 v159, v26 offset:24320
ds_read_b32 v160, v26 offset:24576
ds_read_b32 v161, v26 offset:24832
ds_read_b32 v162, v26 offset:25088
ds_read_b32 v163, v26 offset:25344
ds_read_b32 v164, v26 offset:25600
ds_read_b32 v165, v26 offset:25856
ds_read_b32 v166, v26 offset:26112
ds_read_b32 v167, v26 offset:26368
ds_read_b32 v168, v26 offset:26624
ds_read_b32 v169, v26 offset:26880
ds_read_b32 v170, v26 offset:27136
ds_read_b32 v171, v26 offset:27392
ds_read_b32 v172, v26 offset:27648
ds_read_b32 v173, v26 offset:27904
ds_read_b32 v174, v26 offset:28160
ds_read_b32 v175, v26 offset:28416
ds_read_b32 v176, v26 offset:28672
ds_read_b32 v177, v26 offset:28928
ds_read_b32 v178, v26 offset:29184
ds_read_b32 v179, v26 offset:29440
ds_read_b32 v180, v26 offset:29696
ds_read_b32 v181, v26 offset:29952
ds_read_b32 v182, v26 offset:30208
ds_read_b32 v183, v26 offset:30464
ds_read_b32 v184, v26 offset:30720
ds_read_b32 v185, v26 offset:30976
ds_read_b32 v186, v26 offset:31232
ds_read_b32 v187, v26 offset:31488
ds_read_b32 v188, v26 offset:31744
ds_read_b32 v189, v26 offset:32000
ds_read_b32 v190, v26 offset:32256
ds_read_b32 v191, v26 offset:32512
s_waitcnt lgkmcnt(0)
v_add_f32 v4, v128, v129
v_add_f32 v4, v4, v130
v_add_f32 v4, v4, v131
v_add_f32 v4, v4, v132
v_add_f32 v4, v4, v133
v_add_f32 v4, v4, v134
v_add_f32 v4, v4, v135
v_add_f32 v4, v4, v136
v_add_f32 v4, v4, v137
v_add_f32 v4, v4, v138
v_add_f32 v4, v4, v139
v_add_f32 v4, v4, v140
v_add_f32 v4, v4, v141
v_add_f32 v4, v4, v142
v_add_f32 v4, v4, v143
v_add_f32 v4, v4, v144
v_add_f32 v4, v4, v145
v_add_f32 v4, v4, v146
v_add_f32 v4, v4, v147
v_add_f32 v4, v4, v148
v_add_f32 v4, v4, v149
v_add_f32 v4, v4, v150
v_add_f32 v4, v4, v151
v_add_f32 v4, v4, v152
v_add_f32 v4, v4, v153
v_add_f32 v4, v4, v154
v_add_f32 v4, v4, v155
v_add_f32 v4, v4, v156
v_add_f32 v4, v4, v157
v_add_f32 v4, v4, v158
v_add_f32 v4, v4, v159
v_add_f32 v4, v4, v160
v_add_f32 v4, v4, v161
v_add_f32 v4, v4, v162
v_add_f32 v4, v4, v163
v_add_f32 v4, v4, v164
v_add_f32 v4, v4, v165
v_add_f32 v4, v4, v166
v_add_f32 v4, v4, v167
v_add_f32 v4, v4, v168
v_add_f32 v4, v4, v169
v_add_f32 v4, v4, v170
v_add_f32 v4, v4, v171
v_add_f32 v4, v4, v172
v_add_f32 v4, v4, v173
v_add_f32 v4, v4, v174
v_add_f32 v4, v4, v175
v_add_f32 v4, v4, v176
v_add_f32 v4, v4, v177
v_add_f32 v4, v4, v178
v_add_f32 v4, v4, v179
v_add_f32 v4, v4, v180
v_add_f32 v4, v4, v181
v_add_f32 v4, v4, v182
v_add_f32 v4, v4, v183
v_add_f32 v4, v4, v184
v_add_f32 v4, v4, v185
v_add_f32 v4, v4, v186
v_add_f32 v4, v4, v187
v_add_f32 v4, v4, v188
v_add_f32 v4, v4, v189
v_add_f32 v4, v4, v190
v_add_f32 v4, v4, v191
v_cvt_pk_bf16_f32 v4, 0, v4
s_lshl_b32 s9, s6, 8
v_lshlrev_b32 v26, 2, v1
v_add_u32 v26, s9, v26
ds_write_b32 v26, v4 offset:6016
L_ffn_a:
s_waitcnt lgkmcnt(0)
s_barrier
s_cmp_eq_u32 s6, 0
s_cbranch_scc0 L_ffn_b
v_lshlrev_b32 v26, 2, v1
ds_read_b32 v4, v26 offset:6016
ds_read_b32 v5, v26 offset:6272
s_waitcnt lgkmcnt(0)
v_mul_f32 v6, 0xbfb8aa3b, v4
v_exp_f32 v6, v6
s_nop 0
v_add_f32 v6, 1.0, v6
v_rcp_f32 v7, v6
s_nop 0
v_mul_f32 v8, v4, v7
v_fma_f32 v9, -v8, v6, v4
v_fma_f32 v8, v9, v7, v8
v_cvt_pk_bf16_f32 v8, 0, v8
v_mul_f32 v8, v8, v5
v_cvt_pk_bf16_f32 v8, 0, v8
ds_write_b32 v26, v8 offset:6528
L_ffn_b:
s_waitcnt lgkmcnt(0)
s_barrier
s_lshl_b32 s9, s6, 4
v_mov_b32 v26, s9
ds_read_b128 v[20:23], v26 offset:6528
ds_read_b128 v[24:27], v26 offset:6656
v_mov_b32 v4, 0
v_mov_b32 v5, 0
v_mov_b32 v6, 0
v_mov_b32 v7, 0
v_mov_b32 v8, 0
v_mov_b32 v9, 0
v_mov_b32 v10, 0
v_mov_b32 v11, 0
v_mov_b32 v12, 0
v_mov_b32 v13, 0
v_mov_b32 v14, 0
v_mov_b32 v15, 0
v_mov_b32 v16, 0
v_mov_b32 v17, 0
v_mov_b32 v18, 0
v_mov_b32 v19, 0
s_waitcnt lgkmcnt(0)
s_waitcnt vmcnt(0)
v_lshlrev_b32 v28, 16, v192
v_and_b32 v29, s14, v192
v_fmac_f32 v4, v20, v28
v_fmac_f32 v5, v20, v29
v_fmac_f32 v12, v24, v28
v_fmac_f32 v13, v24, v29
v_lshlrev_b32 v28, 16, v193
v_and_b32 v29, s14, v193
v_fmac_f32 v6, v20, v28
v_fmac_f32 v7, v20, v29
v_fmac_f32 v14, v24, v28
v_fmac_f32 v15, v24, v29
v_lshlrev_b32 v28, 16, v194
v_and_b32 v29, s14, v194
v_fmac_f32 v8, v20, v28
v_fmac_f32 v9, v20, v29
v_fmac_f32 v16, v24, v28
v_fmac_f32 v17, v24, v29
v_lshlrev_b32 v28, 16, v195
v_and_b32 v29, s14, v195
v_fmac_f32 v10, v20, v28
v_fmac_f32 v11, v20, v29
v_fmac_f32 v18, v24, v28
v_fmac_f32 v19, v24, v29
v_lshlrev_b32 v28, 16, v196
v_and_b32 v29, s14, v196
v_fmac_f32 v4, v21, v28
v_fmac_f32 v5, v21, v29
v_fmac_f32 v12, v25, v28
v_fmac_f32 v13, v25, v29
v_lshlrev_b32 v28, 16, v197
v_and_b32 v29, s14, v197
v_fmac_f32 v6, v21, v28
v_fmac_f32 v7, v21, v29
v_fmac_f32 v14, v25, v28
v_fmac_f32 v15, v25, v29
v_lshlrev_b32 v28, 16, v198
v_and_b32 v29, s14, v198
v_fmac_f32 v8, v21, v28
v_fmac_f32 v9, v21, v29
v_fmac_f32 v16, v25, v28
v_fmac_f32 v17, v25, v29
v_lshlrev_b32 v28, 16, v199
v_and_b32 v29, s14, v199
v_fmac_f32 v10, v21, v28
v_fmac_f32 v11, v21, v29
v_fmac_f32 v18, v25, v28
v_fmac_f32 v19, v25, v29
v_lshlrev_b32 v28, 16, v200
v_and_b32 v29, s14, v200
v_fmac_f32 v4, v22, v28
v_fmac_f32 v5, v22, v29
v_fmac_f32 v12, v26, v28
v_fmac_f32 v13, v26, v29
v_lshlrev_b32 v28, 16, v201
v_and_b32 v29, s14, v201
v_fmac_f32 v6, v22, v28
v_fmac_f32 v7, v22, v29
v_fmac_f32 v14, v26, v28
v_fmac_f32 v15, v26, v29
v_lshlrev_b32 v28, 16, v202
v_and_b32 v29, s14, v202
v_fmac_f32 v8, v22, v28
v_fmac_f32 v9, v22, v29
v_fmac_f32 v16, v26, v28
v_fmac_f32 v17, v26, v29
v_lshlrev_b32 v28, 16, v203
v_and_b32 v29, s14, v203
v_fmac_f32 v10, v22, v28
v_fmac_f32 v11, v22, v29
v_fmac_f32 v18, v26, v28
v_fmac_f32 v19, v26, v29
v_lshlrev_b32 v28, 16, v204
v_and_b32 v29, s14, v204
v_fmac_f32 v4, v23, v28
v_fmac_f32 v5, v23, v29
v_fmac_f32 v12, v27, v28
v_fmac_f32 v13, v27, v29
v_lshlrev_b32 v28, 16, v205
v_and_b32 v29, s14, v205
v_fmac_f32 v6, v23, v28
v_fmac_f32 v7, v23, v29
v_fmac_f32 v14, v27, v28
v_fmac_f32 v15, v27, v29
v_lshlrev_b32 v28, 16, v206
v_and_b32 v29, s14, v206
v_fmac_f32 v8, v23, v28
v_fmac_f32 v9, v23, v29
v_fmac_f32 v16, v27, v28
v_fmac_f32 v17, v27, v29
v_lshlrev_b32 v28, 16, v207
v_and_b32 v29, s14, v207
v_fmac_f32 v10, v23, v28
v_fmac_f32 v11, v23, v29
v_fmac_f32 v18, v27, v28
v_fmac_f32 v19, v27, v29
s_mul_i32 s15, s5, 7168
s_add_u32 s15, s15, 0x101000
s_mov_b32 s5, 99
s_branch L_tail
L_cmb:
s_sub_u32 s5, s5, 56
s_lshr_b32 s3, s5, 2
s_and_b32 s4, s5, 3
s_lshl_b32 s9, s5, 3
s_add_u32 s9, s9, s6
s_mul_i32 s9, s9, 7168
buffer_load_dwordx4 v[224:227], v31, s[56:59], s9 offen offset:0 nt
buffer_load_dwordx4 v[228:231], v31, s[56:59], s9 offen offset:896 nt
buffer_load_dwordx4 v[232:235], v31, s[56:59], s9 offen offset:1792 nt
buffer_load_dwordx4 v[236:239], v31, s[56:59], s9 offen offset:2688 nt
s_add_u32 s9, s9, 3584
buffer_load_dwordx4 v[240:243], v31, s[56:59], s9 offen offset:0 nt
buffer_load_dwordx4 v[244:247], v31, s[56:59], s9 offen offset:896 nt
buffer_load_dwordx4 v[248:251], v31, s[56:59], s9 offen offset:1792 nt
buffer_load_dwordx4 v[252:255], v31, s[56:59], s9 offen offset:2688 nt
s_cmp_eq_u32 s6, 0
s_cbranch_scc0 L_cmb_w
v_bfe_u32 v28, v1, 3, 1
v_lshlrev_b32 v28, 11, v28
v_and_b32 v29, 7, v1
v_lshl_add_u32 v28, v29, 4, v28
s_lshl_b32 s9, s3, 7
s_add_u32 s9, s9, 0x90000
s_mov_b64 exec, 0xffff
L_cpoll:
buffer_load_dwordx4 v[4:7], v28, s[76:79], s9 offen sc1
s_waitcnt vmcnt(0)
v_cmp_eq_u32 vcc, s16, v5
v_cmp_eq_u32 s[80:81], s16, v7
s_nop 3
s_and_b64 vcc, vcc, s[80:81]
s_cmp_eq_u64 vcc, exec
s_cbranch_scc1 L_cgot
s_sleep 8
s_branch L_cpoll
L_cgot:
s_mov_b64 exec, -1
L_cmb_w:
s_barrier
v_and_b32 v4, 7, v1
v_bfe_u32 v5, v1, 3, 1
v_lshlrev_b32 v6, 18, v5
v_lshl_add_u32 v6, v4, 3, v6
v_lshlrev_b32 v7, 11, v5
L_cload:
s_lshl_b32 s9, s3, 14
s_lshl_b32 s10, s4, 9
s_add_u32 s9, s9, s10
s_lshl_b32 s10, s6, 6
s_add_u32 s9, s9, s10
s_add_u32 s9, s9, 0x10000
buffer_load_dwordx2 v[128:129], v6, s[76:79], s9 offen offset:0 sc1
buffer_load_dwordx2 v[130:131], v6, s[76:79], s9 offen offset:2048 sc1
s_add_u32 s9, s9, 4096
buffer_load_dwordx2 v[132:133], v6, s[76:79], s9 offen offset:0 sc1
buffer_load_dwordx2 v[134:135], v6, s[76:79], s9 offen offset:2048 sc1
s_add_u32 s9, s9, 4096
buffer_load_dwordx2 v[136:137], v6, s[76:79], s9 offen offset:0 sc1
buffer_load_dwordx2 v[138:139], v6, s[76:79], s9 offen offset:2048 sc1
s_add_u32 s9, s9, 4096
buffer_load_dwordx2 v[140:141], v6, s[76:79], s9 offen offset:0 sc1
buffer_load_dwordx2 v[142:143], v6, s[76:79], s9 offen offset:2048 sc1
s_lshl_b32 s9, s3, 7
s_add_u32 s9, s9, 0x90000
buffer_load_dwordx4 v[144:147], v7, s[76:79], s9 offen offset:0 sc1
buffer_load_dwordx4 v[148:151], v7, s[76:79], s9 offen offset:16 sc1
buffer_load_dwordx4 v[152:155], v7, s[76:79], s9 offen offset:32 sc1
buffer_load_dwordx4 v[156:159], v7, s[76:79], s9 offen offset:48 sc1
buffer_load_dwordx4 v[160:163], v7, s[76:79], s9 offen offset:64 sc1
buffer_load_dwordx4 v[164:167], v7, s[76:79], s9 offen offset:80 sc1
buffer_load_dwordx4 v[168:171], v7, s[76:79], s9 offen offset:96 sc1
buffer_load_dwordx4 v[172:175], v7, s[76:79], s9 offen offset:112 sc1
s_waitcnt vmcnt(0)
s_mov_b64 s[82:83], -1
v_cmp_eq_u32 vcc, s16, v129
s_nop 3
s_and_b64 s[82:83], s[82:83], vcc
v_cmp_eq_u32 vcc, s16, v131
s_nop 3
s_and_b64 s[82:83], s[82:83], vcc
v_cmp_eq_u32 vcc, s16, v133
s_nop 3
s_and_b64 s[82:83], s[82:83], vcc
v_cmp_eq_u32 vcc, s16, v135
s_nop 3
s_and_b64 s[82:83], s[82:83], vcc
v_cmp_eq_u32 vcc, s16, v137
s_nop 3
s_and_b64 s[82:83], s[82:83], vcc
v_cmp_eq_u32 vcc, s16, v139
s_nop 3
s_and_b64 s[82:83], s[82:83], vcc
v_cmp_eq_u32 vcc, s16, v141
s_nop 3
s_and_b64 s[82:83], s[82:83], vcc
v_cmp_eq_u32 vcc, s16, v143
s_nop 3
s_and_b64 s[82:83], s[82:83], vcc
s_cmp_eq_u64 s[82:83], -1
s_cbranch_scc0 L_cload
v_max3_f32 v10, v144, v148, v152
v_max3_f32 v10, v10, v156, v160
v_max3_f32 v10, v10, v164, v168
v_max_f32 v10, v10, v172
v_mov_b32 v11, 0
v_mov_b32 v12, 0
v_sub_f32 v13, v144, v10
v_mul_f32 v13, s13, v13
v_exp_f32 v13, v13
s_nop 0
v_fmac_f32 v11, v13, v146
v_fmac_f32 v12, v13, v128
v_sub_f32 v13, v148, v10
v_mul_f32 v13, s13, v13
v_exp_f32 v13, v13
s_nop 0
v_fmac_f32 v11, v13, v150
v_fmac_f32 v12, v13, v130
v_sub_f32 v13, v152, v10
v_mul_f32 v13, s13, v13
v_exp_f32 v13, v13
s_nop 0
v_fmac_f32 v11, v13, v154
v_fmac_f32 v12, v13, v132
v_sub_f32 v13, v156, v10
v_mul_f32 v13, s13, v13
v_exp_f32 v13, v13
s_nop 0
v_fmac_f32 v11, v13, v158
v_fmac_f32 v12, v13, v134
v_sub_f32 v13, v160, v10
v_mul_f32 v13, s13, v13
v_exp_f32 v13, v13
s_nop 0
v_fmac_f32 v11, v13, v162
v_fmac_f32 v12, v13, v136
v_sub_f32 v13, v164, v10
v_mul_f32 v13, s13, v13
v_exp_f32 v13, v13
s_nop 0
v_fmac_f32 v11, v13, v166
v_fmac_f32 v12, v13, v138
v_sub_f32 v13, v168, v10
v_mul_f32 v13, s13, v13
v_exp_f32 v13, v13
s_nop 0
v_fmac_f32 v11, v13, v170
v_fmac_f32 v12, v13, v140
v_sub_f32 v13, v172, v10
v_mul_f32 v13, s13, v13
v_exp_f32 v13, v13
s_nop 0
v_fmac_f32 v11, v13, v174
v_fmac_f32 v12, v13, v142
v_rcp_f32 v13, v11
s_nop 0
v_mul_f32 v14, v12, v13
v_fma_f32 v15, -v14, v11, v12
v_fma_f32 v14, v15, v13, v14
v_cvt_pk_bf16_f32 v14, 0, v14
s_nop 0
v_readlane_b32 s20, v14, 0
v_readlane_b32 s21, v14, 1
v_readlane_b32 s22, v14, 2
v_readlane_b32 s23, v14, 3
v_readlane_b32 s24, v14, 4
v_readlane_b32 s25, v14, 5
v_readlane_b32 s26, v14, 6
v_readlane_b32 s27, v14, 7
v_readlane_b32 s28, v14, 8
v_readlane_b32 s29, v14, 9
v_readlane_b32 s30, v14, 10
v_readlane_b32 s31, v14, 11
v_readlane_b32 s32, v14, 12
v_readlane_b32 s33, v14, 13
v_readlane_b32 s34, v14, 14
v_readlane_b32 s35, v14, 15
v_mov_b32 v4, 0
v_mov_b32 v5, 0
v_mov_b32 v6, 0
v_mov_b32 v7, 0
v_mov_b32 v8, 0
v_mov_b32 v9, 0
v_mov_b32 v10, 0
v_mov_b32 v11, 0
v_mov_b32 v12, 0
v_mov_b32 v13, 0
v_mov_b32 v14, 0
v_mov_b32 v15, 0
v_mov_b32 v16, 0
v_mov_b32 v17, 0
v_mov_b32 v18, 0
v_mov_b32 v19, 0
v_lshlrev_b32 v28, 16, v224
v_and_b32 v29, s14, v224
v_fmac_f32 v4, s20, v28
v_fmac_f32 v5, s20, v29
v_fmac_f32 v12, s28, v28
v_fmac_f32 v13, s28, v29
v_lshlrev_b32 v28, 16, v225
v_and_b32 v29, s14, v225
v_fmac_f32 v6, s20, v28
v_fmac_f32 v7, s20, v29
v_fmac_f32 v14, s28, v28
v_fmac_f32 v15, s28, v29
v_lshlrev_b32 v28, 16, v226
v_and_b32 v29, s14, v226
v_fmac_f32 v8, s20, v28
v_fmac_f32 v9, s20, v29
v_fmac_f32 v16, s28, v28
v_fmac_f32 v17, s28, v29
v_lshlrev_b32 v28, 16, v227
v_and_b32 v29, s14, v227
v_fmac_f32 v10, s20, v28
v_fmac_f32 v11, s20, v29
v_fmac_f32 v18, s28, v28
v_fmac_f32 v19, s28, v29
v_lshlrev_b32 v28, 16, v228
v_and_b32 v29, s14, v228
v_fmac_f32 v4, s21, v28
v_fmac_f32 v5, s21, v29
v_fmac_f32 v12, s29, v28
v_fmac_f32 v13, s29, v29
v_lshlrev_b32 v28, 16, v229
v_and_b32 v29, s14, v229
v_fmac_f32 v6, s21, v28
v_fmac_f32 v7, s21, v29
v_fmac_f32 v14, s29, v28
v_fmac_f32 v15, s29, v29
v_lshlrev_b32 v28, 16, v230
v_and_b32 v29, s14, v230
v_fmac_f32 v8, s21, v28
v_fmac_f32 v9, s21, v29
v_fmac_f32 v16, s29, v28
v_fmac_f32 v17, s29, v29
v_lshlrev_b32 v28, 16, v231
v_and_b32 v29, s14, v231
v_fmac_f32 v10, s21, v28
v_fmac_f32 v11, s21, v29
v_fmac_f32 v18, s29, v28
v_fmac_f32 v19, s29, v29
v_lshlrev_b32 v28, 16, v232
v_and_b32 v29, s14, v232
v_fmac_f32 v4, s22, v28
v_fmac_f32 v5, s22, v29
v_fmac_f32 v12, s30, v28
v_fmac_f32 v13, s30, v29
v_lshlrev_b32 v28, 16, v233
v_and_b32 v29, s14, v233
v_fmac_f32 v6, s22, v28
v_fmac_f32 v7, s22, v29
v_fmac_f32 v14, s30, v28
v_fmac_f32 v15, s30, v29
v_lshlrev_b32 v28, 16, v234
v_and_b32 v29, s14, v234
v_fmac_f32 v8, s22, v28
v_fmac_f32 v9, s22, v29
v_fmac_f32 v16, s30, v28
v_fmac_f32 v17, s30, v29
v_lshlrev_b32 v28, 16, v235
v_and_b32 v29, s14, v235
v_fmac_f32 v10, s22, v28
v_fmac_f32 v11, s22, v29
v_fmac_f32 v18, s30, v28
v_fmac_f32 v19, s30, v29
v_lshlrev_b32 v28, 16, v236
v_and_b32 v29, s14, v236
v_fmac_f32 v4, s23, v28
v_fmac_f32 v5, s23, v29
v_fmac_f32 v12, s31, v28
v_fmac_f32 v13, s31, v29
v_lshlrev_b32 v28, 16, v237
v_and_b32 v29, s14, v237
v_fmac_f32 v6, s23, v28
v_fmac_f32 v7, s23, v29
v_fmac_f32 v14, s31, v28
v_fmac_f32 v15, s31, v29
v_lshlrev_b32 v28, 16, v238
v_and_b32 v29, s14, v238
v_fmac_f32 v8, s23, v28
v_fmac_f32 v9, s23, v29
v_fmac_f32 v16, s31, v28
v_fmac_f32 v17, s31, v29
v_lshlrev_b32 v28, 16, v239
v_and_b32 v29, s14, v239
v_fmac_f32 v10, s23, v28
v_fmac_f32 v11, s23, v29
v_fmac_f32 v18, s31, v28
v_fmac_f32 v19, s31, v29
v_lshlrev_b32 v28, 16, v240
v_and_b32 v29, s14, v240
v_fmac_f32 v4, s24, v28
v_fmac_f32 v5, s24, v29
v_fmac_f32 v12, s32, v28
v_fmac_f32 v13, s32, v29
v_lshlrev_b32 v28, 16, v241
v_and_b32 v29, s14, v241
v_fmac_f32 v6, s24, v28
v_fmac_f32 v7, s24, v29
v_fmac_f32 v14, s32, v28
v_fmac_f32 v15, s32, v29
v_lshlrev_b32 v28, 16, v242
v_and_b32 v29, s14, v242
v_fmac_f32 v8, s24, v28
v_fmac_f32 v9, s24, v29
v_fmac_f32 v16, s32, v28
v_fmac_f32 v17, s32, v29
v_lshlrev_b32 v28, 16, v243
v_and_b32 v29, s14, v243
v_fmac_f32 v10, s24, v28
v_fmac_f32 v11, s24, v29
v_fmac_f32 v18, s32, v28
v_fmac_f32 v19, s32, v29
v_lshlrev_b32 v28, 16, v244
v_and_b32 v29, s14, v244
v_fmac_f32 v4, s25, v28
v_fmac_f32 v5, s25, v29
v_fmac_f32 v12, s33, v28
v_fmac_f32 v13, s33, v29
v_lshlrev_b32 v28, 16, v245
v_and_b32 v29, s14, v245
v_fmac_f32 v6, s25, v28
v_fmac_f32 v7, s25, v29
v_fmac_f32 v14, s33, v28
v_fmac_f32 v15, s33, v29
v_lshlrev_b32 v28, 16, v246
v_and_b32 v29, s14, v246
v_fmac_f32 v8, s25, v28
v_fmac_f32 v9, s25, v29
v_fmac_f32 v16, s33, v28
v_fmac_f32 v17, s33, v29
v_lshlrev_b32 v28, 16, v247
v_and_b32 v29, s14, v247
v_fmac_f32 v10, s25, v28
v_fmac_f32 v11, s25, v29
v_fmac_f32 v18, s33, v28
v_fmac_f32 v19, s33, v29
v_lshlrev_b32 v28, 16, v248
v_and_b32 v29, s14, v248
v_fmac_f32 v4, s26, v28
v_fmac_f32 v5, s26, v29
v_fmac_f32 v12, s34, v28
v_fmac_f32 v13, s34, v29
v_lshlrev_b32 v28, 16, v249
v_and_b32 v29, s14, v249
v_fmac_f32 v6, s26, v28
v_fmac_f32 v7, s26, v29
v_fmac_f32 v14, s34, v28
v_fmac_f32 v15, s34, v29
v_lshlrev_b32 v28, 16, v250
v_and_b32 v29, s14, v250
v_fmac_f32 v8, s26, v28
v_fmac_f32 v9, s26, v29
v_fmac_f32 v16, s34, v28
v_fmac_f32 v17, s34, v29
v_lshlrev_b32 v28, 16, v251
v_and_b32 v29, s14, v251
v_fmac_f32 v10, s26, v28
v_fmac_f32 v11, s26, v29
v_fmac_f32 v18, s34, v28
v_fmac_f32 v19, s34, v29
v_lshlrev_b32 v28, 16, v252
v_and_b32 v29, s14, v252
v_fmac_f32 v4, s27, v28
v_fmac_f32 v5, s27, v29
v_fmac_f32 v12, s35, v28
v_fmac_f32 v13, s35, v29
v_lshlrev_b32 v28, 16, v253
v_and_b32 v29, s14, v253
v_fmac_f32 v6, s27, v28
v_fmac_f32 v7, s27, v29
v_fmac_f32 v14, s35, v28
v_fmac_f32 v15, s35, v29
v_lshlrev_b32 v28, 16, v254
v_and_b32 v29, s14, v254
v_fmac_f32 v8, s27, v28
v_fmac_f32 v9, s27, v29
v_fmac_f32 v16, s35, v28
v_fmac_f32 v17, s35, v29
v_lshlrev_b32 v28, 16, v255
v_and_b32 v29, s14, v255
v_fmac_f32 v10, s27, v28
v_fmac_f32 v11, s27, v29
v_fmac_f32 v18, s35, v28
v_fmac_f32 v19, s35, v29
s_mul_i32 s15, s5, 7168
s_add_u32 s15, s15, 0x91000
L_tail:
s_mul_i32 s9, s6, 3584
s_add_u32 s9, s9, 49152
v_lshlrev_b32 v28, 5, v1
v_add_u32 v28, s9, v28
s_mov_b32 exec_hi, 0x00ffffff
ds_write_b128 v28, v[4:7]
ds_write_b128 v28, v[8:11] offset:16
ds_write_b128 v28, v[12:15] offset:1792
ds_write_b128 v28, v[16:19] offset:1808
s_mov_b32 exec_hi, -1
s_waitcnt lgkmcnt(0)
s_barrier
v_cmp_gt_u32 vcc, 224, v0
s_and_saveexec_b64 s[80:81], vcc
s_cbranch_execz L_pt_c
v_lshlrev_b32 v28, 4, v0
v_add_u32 v29, 49152, v28
ds_read_b128 v[64:67], v29 offset:0
ds_read_b128 v[68:71], v29 offset:3584
ds_read_b128 v[72:75], v29 offset:7168
ds_read_b128 v[76:79], v29 offset:10752
ds_read_b128 v[80:83], v29 offset:14336
ds_read_b128 v[84:87], v29 offset:17920
ds_read_b128 v[88:91], v29 offset:21504
ds_read_b128 v[92:95], v29 offset:25088
s_waitcnt lgkmcnt(0)
v_add_f32 v64, v64, v68
v_add_f32 v65, v65, v69
v_add_f32 v66, v66, v70
v_add_f32 v67, v67, v71
v_add_f32 v64, v64, v72
v_add_f32 v65, v65, v73
v_add_f32 v66, v66, v74
v_add_f32 v67, v67, v75
v_add_f32 v64, v64, v76
v_add_f32 v65, v65, v77
v_add_f32 v66, v66, v78
v_add_f32 v67, v67, v79
v_add_f32 v64, v64, v80
v_add_f32 v65, v65, v81
v_add_f32 v66, v66, v82
v_add_f32 v67, v67, v83
v_add_f32 v64, v64, v84
v_add_f32 v65, v65, v85
v_add_f32 v66, v66, v86
v_add_f32 v67, v67, v87
v_add_f32 v64, v64, v88
v_add_f32 v65, v65, v89
v_add_f32 v66, v66, v90
v_add_f32 v67, v67, v91
v_add_f32 v64, v64, v92
v_add_f32 v65, v65, v93
v_add_f32 v66, v66, v94
v_add_f32 v67, v67, v95
v_mov_b32 v72, v64
v_mov_b32 v73, s16
v_mov_b32 v74, v65
v_mov_b32 v75, s16
v_mov_b32 v76, v66
v_mov_b32 v77, s16
v_mov_b32 v78, v67
v_mov_b32 v79, s16
v_lshlrev_b32 v28, 5, v0
buffer_store_dwordx4 v[72:75], v28, s[76:79], s15 offen sc1
buffer_store_dwordx4 v[76:79], v28, s[76:79], s15 offen offset:16 sc1
L_pt_c:
s_mov_b64 exec, -1
s_cmp_ge_u32 s5, 14
s_cbranch_scc1 L_fin_end
s_and_b32 s4, s5, 1
s_lshr_b32 s5, s5, 1
v_lshlrev_b32 v6, 3, v1
s_lshl_b32 s10, s5, 9
v_add_u32 v6, s10, v6
v_lshrrev_b32 v7, 2, v6
s_mul_i32 s10, s4, 896
buffer_load_ushort v100, v7, s[40:43], s10 offen
s_mul_i32 s15, s4, 3584
L_fpoll:
s_mul_i32 s10, s6, 57344
s_add_u32 s10, s10, s15
s_add_u32 s10, s10, 0x91000
buffer_load_dwordx2 v[64:65], v6, s[76:79], s10 offen sc1
s_add_u32 s10, s10, 7168
buffer_load_dwordx2 v[66:67], v6, s[76:79], s10 offen sc1
s_add_u32 s10, s10, 7168
buffer_load_dwordx2 v[68:69], v6, s[76:79], s10 offen sc1
s_add_u32 s10, s10, 7168
buffer_load_dwordx2 v[70:71], v6, s[76:79], s10 offen sc1
s_add_u32 s10, s10, 7168
buffer_load_dwordx2 v[72:73], v6, s[76:79], s10 offen sc1
s_add_u32 s10, s10, 7168
buffer_load_dwordx2 v[74:75], v6, s[76:79], s10 offen sc1
s_add_u32 s10, s10, 7168
buffer_load_dwordx2 v[76:77], v6, s[76:79], s10 offen sc1
s_add_u32 s10, s10, 7168
buffer_load_dwordx2 v[78:79], v6, s[76:79], s10 offen sc1
s_add_u32 s10, s10, 7168
s_mul_i32 s10, s6, 50176
s_add_u32 s10, s10, s15
s_add_u32 s10, s10, 0x101000
buffer_load_dwordx2 v[80:81], v6, s[76:79], s10 offen sc1
s_add_u32 s10, s10, 7168
buffer_load_dwordx2 v[82:83], v6, s[76:79], s10 offen sc1
s_add_u32 s10, s10, 7168
buffer_load_dwordx2 v[84:85], v6, s[76:79], s10 offen sc1
s_add_u32 s10, s10, 7168
buffer_load_dwordx2 v[86:87], v6, s[76:79], s10 offen sc1
s_add_u32 s10, s10, 7168
buffer_load_dwordx2 v[88:89], v6, s[76:79], s10 offen sc1
s_add_u32 s10, s10, 7168
buffer_load_dwordx2 v[90:91], v6, s[76:79], s10 offen sc1
s_add_u32 s10, s10, 7168
buffer_load_dwordx2 v[92:93], v6, s[76:79], s10 offen sc1
s_add_u32 s10, s10, 7168
s_waitcnt vmcnt(0)
s_mov_b64 s[82:83], -1
v_cmp_eq_u32 vcc, s16, v65
s_nop 3
s_and_b64 s[82:83], s[82:83], vcc
v_cmp_eq_u32 vcc, s16, v67
s_nop 3
s_and_b64 s[82:83], s[82:83], vcc
v_cmp_eq_u32 vcc, s16, v69
s_nop 3
s_and_b64 s[82:83], s[82:83], vcc
v_cmp_eq_u32 vcc, s16, v71
s_nop 3
s_and_b64 s[82:83], s[82:83], vcc
v_cmp_eq_u32 vcc, s16, v73
s_nop 3
s_and_b64 s[82:83], s[82:83], vcc
v_cmp_eq_u32 vcc, s16, v75
s_nop 3
s_and_b64 s[82:83], s[82:83], vcc
v_cmp_eq_u32 vcc, s16, v77
s_nop 3
s_and_b64 s[82:83], s[82:83], vcc
v_cmp_eq_u32 vcc, s16, v79
s_nop 3
s_and_b64 s[82:83], s[82:83], vcc
v_cmp_eq_u32 vcc, s16, v81
s_nop 3
s_and_b64 s[82:83], s[82:83], vcc
v_cmp_eq_u32 vcc, s16, v83
s_nop 3
s_and_b64 s[82:83], s[82:83], vcc
v_cmp_eq_u32 vcc, s16, v85
s_nop 3
s_and_b64 s[82:83], s[82:83], vcc
v_cmp_eq_u32 vcc, s16, v87
s_nop 3
s_and_b64 s[82:83], s[82:83], vcc
v_cmp_eq_u32 vcc, s16, v89
s_nop 3
s_and_b64 s[82:83], s[82:83], vcc
v_cmp_eq_u32 vcc, s16, v91
s_nop 3
s_and_b64 s[82:83], s[82:83], vcc
v_cmp_eq_u32 vcc, s16, v93
s_nop 3
s_and_b64 s[82:83], s[82:83], vcc
s_cmp_eq_u64 s[82:83], -1
s_cbranch_scc1 L_fgot
s_sleep 4
s_branch L_fpoll
L_fgot:
v_add_f32 v8, v64, v66
v_add_f32 v8, v8, v68
v_add_f32 v8, v8, v70
v_add_f32 v8, v8, v72
v_add_f32 v8, v8, v74
v_add_f32 v8, v8, v76
v_add_f32 v8, v8, v78
v_add_f32 v9, v80, v82
v_add_f32 v9, v9, v84
v_add_f32 v9, v9, v86
v_add_f32 v9, v9, v88
v_add_f32 v9, v9, v90
v_add_f32 v9, v9, v92
s_lshl_b32 s9, s6, 8
v_lshlrev_b32 v10, 2, v1
v_add_u32 v10, s9, v10
ds_write_b32 v10, v8 offset:8192
ds_write_b32 v10, v9 offset:10240
s_waitcnt lgkmcnt(0)
s_barrier
s_cmp_eq_u32 s6, 0
s_cbranch_scc0 L_fin_end
v_lshlrev_b32 v10, 2, v1
ds_read_b32 v12, v10 offset:8192
ds_read_b32 v20, v10 offset:10240
ds_read_b32 v13, v10 offset:8448
ds_read_b32 v21, v10 offset:10496
ds_read_b32 v14, v10 offset:8704
ds_read_b32 v22, v10 offset:10752
ds_read_b32 v15, v10 offset:8960
ds_read_b32 v23, v10 offset:11008
ds_read_b32 v16, v10 offset:9216
ds_read_b32 v24, v10 offset:11264
ds_read_b32 v17, v10 offset:9472
ds_read_b32 v25, v10 offset:11520
ds_read_b32 v18, v10 offset:9728
ds_read_b32 v26, v10 offset:11776
ds_read_b32 v19, v10 offset:9984
ds_read_b32 v27, v10 offset:12032
s_waitcnt lgkmcnt(0)
v_add_f32 v12, v12, v13
v_add_f32 v20, v20, v21
v_add_f32 v12, v12, v14
v_add_f32 v20, v20, v22
v_add_f32 v12, v12, v15
v_add_f32 v20, v20, v23
v_add_f32 v12, v12, v16
v_add_f32 v20, v20, v24
v_add_f32 v12, v12, v17
v_add_f32 v20, v20, v25
v_add_f32 v12, v12, v18
v_add_f32 v20, v20, v26
v_add_f32 v12, v12, v19
v_add_f32 v20, v20, v27
v_cvt_pk_bf16_f32 v12, 0, v12
v_cvt_pk_bf16_f32 v20, 0, v20
v_lshlrev_b32 v100, 16, v100
v_add_f32 v12, v100, v12
v_cvt_pk_bf16_f32 v12, 0, v12
v_add_f32 v12, v12, v20
v_cvt_pk_bf16_f32 v12, v12, v12
s_mul_i32 s10, s4, 896
buffer_store_short v12, v7, s[68:71], s10 offen
L_fin_end:
L_end:
s_endpgm
.section .rodata,"a"
.p2align 6
.amdhsa_kernel parallel_sum__mha_block_cached__swiglu_ffn__decode_kernel
  .amdhsa_next_free_vgpr 256
  .amdhsa_next_free_sgpr 102
  .amdhsa_accum_offset 256
  .amdhsa_group_segment_fixed_size 0
  .amdhsa_kernarg_size 96
  .amdhsa_user_sgpr_count 2
  .amdhsa_user_sgpr_kernarg_segment_ptr 1
  .amdhsa_system_sgpr_workgroup_id_x 1
.end_amdhsa_kernel
```
